```python
import torch

def _softmax(x, axis=-1):
    return torch.softmax(x, dim=axis)
def _gelu(x):
    return torch.nn.functional.gelu(x, approximate="tanh")
def _silu(x):
    return torch.nn.functional.silu(x)
def _sigmoid(x):
    return torch.sigmoid(x)
def _layernorm(x, axis=-1, eps=1e-5):
    m = x.mean(dim=axis, keepdim=True)
    v = x.var(dim=axis, keepdim=True, unbiased=False)
    return (x - m) / torch.sqrt(v + eps)
def _scatter_add(tgt, idx, src, axis=0):
    return tgt.clone().index_add_(axis, idx, src)
def _segment_sum(src, seg, n):
    out = torch.zeros((n,) + src.shape[1:], dtype=src.dtype)
    return out.index_add_(0, seg, src)
def _pad(x, pw):
    flat = tuple(v for pair in reversed(pw) for v in pair)
    return torch.nn.functional.pad(x, flat)

kernel_name = 'gated_mix__sliding_block_cached__dense_activation_relu__decode'

def setup_inputs():

    _w = (lambda a: (lambda t: t.to(torch.bfloat16) if t.is_floating_point() else t)(torch.as_tensor(a)))
    def _A_setup():
        B, Sq, D = 4, 1, 576
        Hq, Hkv, Sk, Dh = 32, 16, 4096, 128
        assert Hq % Hkv == 0, (Hq, Hkv)
        return {
            "x": _w((lambda *s: torch.randn(*s, dtype=torch.bfloat16) * 0.05)(B, Sq, D)),
            "k_cache": _w((lambda *s: torch.randn(*s, dtype=torch.bfloat16) * 6.4)(B, Hkv, Sk, Dh)),
            "v_cache": _w((lambda *s: torch.randn(*s, dtype=torch.bfloat16) * 0.4)(B, Hkv, Sk, Dh)),
            "wq": _w((lambda *s: torch.randn(*s, dtype=torch.bfloat16) * 6.4)(D, Hq * Dh) * (D ** -0.5)),
            "wo": _w((lambda *s: torch.randn(*s, dtype=torch.bfloat16) * 0.4)(Hq * Dh, D) * ((Hq * Dh) ** -0.5)),
        }
    _A_in = _A_setup()

    def _B_setup():
        B, S, D, Dff = 4, 1, 576, 4608
        return {
            "x": _w((lambda *s: torch.randn(*s, dtype=torch.bfloat16) * 0.05)(B, S, D)),
            "w1": _w((lambda *s: torch.randn(*s, dtype=torch.bfloat16) * 0.05)(D, Dff)),
            "w2": _w((lambda *s: torch.randn(*s, dtype=torch.bfloat16) * 0.05)(Dff, D)),
        }
    _B_in = _B_setup()

    return {
        "A_x": _A_in["x"],
        "A_k_cache": _A_in["k_cache"],
        "A_v_cache": _A_in["v_cache"],
        "A_wq": _A_in["wq"],
        "A_wo": _A_in["wo"],
        "B_x": _B_in["x"],
        "B_w1": _B_in["w1"],
        "B_w2": _B_in["w2"],
        "gate_w": _w((lambda *s: torch.randn(*s, dtype=torch.bfloat16) * 0.05)(576) * 16.0),
    }

def reference(A_x, A_k_cache, A_v_cache, A_wq, A_wo, B_x, B_w1, B_w2, gate_w):
    def _A_ref(x, k_cache, v_cache, wq, wo):
        B, Sq, D = x.shape
        Hq, Dh = 32, 128
        Hkv, Sk = k_cache.shape[1], k_cache.shape[2]
        W = min(4096, max(256, Sk // 4))
        rep = Hq // Hkv
        q = (lambda x, *d: x.permute(*d))((x @ wq).reshape(B, Sq, Hq, Dh), 0, 2, 1, 3)
        k = (lambda x, n, axis: torch.repeat_interleave(x, n, dim=axis))(k_cache[:, :, Sk - W:, :], rep, axis=1)
        v = (lambda x, n, axis: torch.repeat_interleave(x, n, dim=axis))(v_cache[:, :, Sk - W:, :], rep, axis=1)
        scores = torch.einsum("bhqd,bhkd->bhqk", q, k) * (Dh ** -0.5)
        p = _softmax(scores, axis=-1)
        o = torch.einsum("bhqk,bhkd->bhqd", p, v)
        return (lambda x, *d: x.permute(*d))(o, 0, 2, 1, 3).reshape(B, Sq, Hq * Dh) @ wo

    def _B_ref(x, w1, w2):
        h = torch.einsum("bsd,df->bsf", x, w1)
        zero = torch.zeros_like(h)
        h = torch.maximum(h, zero)
        return torch.einsum("bsf,fd->bsd", h, w2)

    x = A_x
    g = _sigmoid((x * gate_w).sum(-1, keepdims=True))
    a = _A_ref(x, A_k_cache, A_v_cache, A_wq, A_wo)
    b = _B_ref(x, B_w1, B_w2)
    return g * a + (1 - g) * b
```

```asm
; @launch grid=(256,1,1) block=(320,1,1) lds=163840
.amdgcn_target "amdgcn-amd-amdhsa--gfx950"
.text
.globl gated_mix__sliding_block_cached__dense_activation_relu__decode_kernel
.p2align 8
.type gated_mix__sliding_block_cached__dense_activation_relu__decode_kernel,@function
gated_mix__sliding_block_cached__dense_activation_relu__decode_kernel:
    s_load_dwordx16 s[24:39], s[0:1], 0
    s_load_dwordx8 s[44:51], s[0:1], 64
    s_getpc_b64 s[52:53]
L_pc:
    s_movk_i32 s54, 10488
    s_mov_b32 s55, 0x20000
    v_mul_u32_u24 v1, 36, v0
    v_lshrrev_b32 v2, 6, v0
    buffer_load_dword v63, v1, s[52:55], 0 offen
    s_cmpk_ge_u32 s2, 256
    s_cbranch_scc1 L_end
    v_readfirstlane_b32 s3, v2
    v_lshlrev_b32 v17, 2, v0
    v_mov_b32 v18, 0
    ds_write_b32 v17, v18 offset:27264
    s_and_b32 s4, s2, 7
    s_bfe_u32 s5, s2, 0x10003
    s_lshl1_add_u32 s4, s4, s5
    s_lshr_b32 s6, s2, 6
    s_bfe_u32 s7, s2, 0x20004
    s_mov_b32 s19, s55
    s_cmp_lg_u32 s3, 0
    s_cbranch_scc1 L_common
    s_setprio 3
    v_lshrrev_b32 v19, 3, v0
    v_and_b32 v20, 6, v19
    v_xor_b32 v20, v20, v0
    v_and_b32 v20, 7, v20
    v_lshlrev_b32 v20, 4, v20
    v_lshl_add_u32 v2, v19, 13, v20
    v_add_u32 v3, 64512, v2
    v_add_u32 v4, 129024, v2
    s_lshl2_add_u32 s57, s4, s6
    s_lshl_b32 s57, s57, 7
    s_mul_i32 s56, s7, 1179648
    s_add_u32 s56, s56, s57
    s_mov_b32 s18, 4718592
    s_mov_b32 m0, 0
    s_waitcnt lgkmcnt(0)
    s_mov_b64 s[16:17], s[30:31]
L_wq:
    buffer_load_dwordx4 v2, s[16:19], s56 offen nt lds
    buffer_load_dwordx4 v3, s[16:19], s56 offen offset:1024 nt lds
    buffer_load_dwordx4 v4, s[16:19], s56 offen offset:2048 nt lds
    s_addk_i32 m0, 3072
    s_add_u32 s56, s56, 196608
    s_cmpk_lt_u32 m0, 18432
    s_cbranch_scc1 L_wq
L_common:
    s_lshr_b32 s5, s2, 4
    s_mov_b32 s63, 131072
    s_lshr_b32 s9, s2, 3
    s_and_b32 s8, s2, 7
    s_lshl_b32 s56, s8, 3
    s_mov_b32 s54, 0x46301800
    s_mov_b32 s55, 0x80706658
    s_mov_b32 s52, 0x12161818
    s_mov_b32 s53, 0x10100a0e
    s_lshr_b64 s[54:55], s[54:55], s56
    s_lshr_b64 s[52:53], s[52:53], s56
    s_and_b32 s54, s54, 0xff
    s_and_b32 s55, s52, 0xff
    s_add_u32 s52, s54, s9
    s_cmp_lt_u32 s9, s55
    s_cselect_b32 s53, 60, 24
    s_sub_u32 s9, s9, 18
    s_sub_u32 s57, s2, 240
    s_cselect_b32 s8, s8, 8
    s_cselect_b32 s9, s9, s57
    s_cselect_b32 s10, 12, 9
    s_mul_i32 s10, s10, s9
    s_cmp_lt_u32 s5, 9
    s_cselect_b32 s8, s5, s8
    s_waitcnt lgkmcnt(0)
    s_cmp_eq_u32 s3, 0
    s_cbranch_scc1 L_ldr
    s_load_dword s11, s[50:51], 0
    s_sub_u32 s3, s3, 1
    v_and_b32 v1, 63, v0
    s_cmp_eq_u32 s3, 1
    s_cbranch_scc0 L_nopf
    s_mov_b64 s[20:21], s[36:37]
    s_mov_b32 s22, 5308416
    s_mov_b32 s23, s19
    s_lshr_b32 s56, s54, 1
    s_lshr_b32 s58, s55, 1
    s_lshr_b32 s57, s20, 7
    s_add_u32 s57, s57, s56
    s_sub_u32 s57, 3, s57
    s_and_b32 s57, s57, 7
    s_add_u32 s59, s57, 8
    s_cmp_lt_u32 s59, s58
    s_cselect_b32 exec_hi, 16383, 0
    s_cmp_lt_u32 s57, s58
    s_cselect_b32 exec_lo, 16383, 0
    s_add_u32 s57, s57, s56
    s_lshl_b32 s57, s57, 7
    s_lshr_b32 s56, s2, 3
    s_and_b32 s58, s56, 1
    s_lshr_b32 s56, s56, 1
    s_mul_i32 s56, s56, 129024
    s_mul_i32 s58, s58, 2654208
    s_add_u32 s56, s56, s58
    s_add_u32 s56, s56, s57
    s_add_u32 s56, s56, 589824
    v_and_b32 v33, 31, v1
    v_mul_u32_u24 v33, 9216, v33
    v_lshrrev_b32 v34, 5, v1
    v_lshl_add_u32 v33, v34, 10, v33
    buffer_load_dword v62, v33, s[20:23], s56 offen
    s_mov_b64 exec, -1
L_nopf:
    s_barrier
    s_branch L_comp
L_ldr:
    s_mov_b64 s[12:13], s[26:27]
    s_movk_i32 s26, 4608
    s_mov_b32 s27, s19
    v_lshlrev_b32 v14, 4, v0
    v_add_u32 v15, 4096, v14
    buffer_load_dwordx4 v14, s[24:27], 0 offen lds
    buffer_load_dwordx4 v14, s[24:27], 0 offen offset:1024 lds
    buffer_load_dwordx4 v14, s[24:27], 0 offen offset:2048 lds
    buffer_load_dwordx4 v14, s[24:27], 0 offen offset:3072 lds
    s_addk_i32 m0, 4096
    s_mov_b32 s14, 67108864
    s_mov_b32 s15, s19
    buffer_load_dwordx4 v15, s[24:27], 0 offen lds
    s_barrier
    v_lshrrev_b32 v16, 4, v0
    v_lshlrev_b32 v16, 5, v16
    v_xor_b32 v15, v14, v16
    v_xor_b32 v16, 128, v15
    v_mov_b32 v18, 24
    s_lshl_b32 s58, s6, 24
    s_lshl_b32 s57, s4, 20
    s_add_u32 s58, s58, s57
    s_lshl_b32 s57, s7, 16
    s_add_u32 s58, s58, s57
    s_add_u32 s58, s58, 0xC0000
    s_lshl_b32 s62, s5, 12
    s_or_b32 s62, s62, s58
    s_cmp_lg_u32 s53, 24
    s_cbranch_scc1 L_ldA
    s_mov_b64 s[20:21], s[38:39]
    v_add_u32 v18, -18, v18
    s_mov_b32 m0, 32768
    s_mov_b32 s60, 98304
L_gKB:
    buffer_load_dwordx4 v15, s[12:15], s62 offen offset:0 nt lds
    buffer_load_dwordx4 v15, s[12:15], s62 offen offset:1024 nt lds
    buffer_load_dwordx4 v16, s[12:15], s62 offen offset:2048 nt lds
    buffer_load_dwordx4 v16, s[12:15], s62 offen offset:3072 nt lds
    s_addk_i32 m0, 4096
    s_addk_i32 s62, 4096
    s_pack_lh_b32_b16 s62, s62, s58
    v_add_u32 v18, 4, v18
    s_waitcnt vmcnt(18)
    ds_max_i32 v17, v18 offset:27264
    s_cmp_lt_u32 m0, s60
    s_cbranch_scc1 L_gKB
    v_mul_u32_u24 v10, 1152, v19
    v_add_u32 v10, v10, v20
    v_add_u32 v11, 8192, v10
    v_add_u32 v12, 16384, v10
    v_add_u32 v13, 24576, v10
    s_mov_b32 s30, s14
    s_mov_b32 s31, s19
    s_lshl_b32 s57, s8, 7
    s_mov_b32 s34, 4718592
    s_mov_b32 s35, s19
    s_mov_b32 s22, 5308416
    s_mov_b32 s23, s19
    s_mul_i32 s56, s4, 294912
    s_mul_i32 s59, s10, 36864
    s_cmp_lt_u32 s5, 9
    s_cselect_b32 s56, s56, s59
    s_add_u32 s56, s56, s57
    v_add_u32 v18, -4, v18
    s_mov_b32 m0, 98304
    s_mov_b32 s60, 163840
L_gVB:
    buffer_load_dwordx4 v15, s[28:31], s62 offen offset:0 nt lds
    buffer_load_dwordx4 v15, s[28:31], s62 offen offset:1024 nt lds
    buffer_load_dwordx4 v16, s[28:31], s62 offen offset:2048 nt lds
    buffer_load_dwordx4 v16, s[28:31], s62 offen offset:3072 nt lds
    s_addk_i32 m0, 4096
    s_addk_i32 s62, 4096
    s_pack_lh_b32_b16 s62, s62, s58
    v_add_u32 v18, 4, v18
    s_waitcnt vmcnt(22)
    ds_max_i32 v17, v18 offset:27264
    s_cmp_lt_u32 m0, s60
    s_cbranch_scc1 L_gVB
    s_cmp_lt_u32 s5, 9
    s_cbranch_scc1 L_ttN
    v_add_u32 v18, 2, v18
    s_waitcnt vmcnt(20)
    ds_max_i32 v17, v18 offset:27264
L_tailB:
Lw_1:
    ds_read_b32 v21, v17 offset:27524
    s_waitcnt lgkmcnt(0)
    v_readfirstlane_b32 s61, v21
    s_cmp_ge_i32 s61, 4
    s_cbranch_scc1 Ld_2
    s_sub_u32 s63, s63, 1
    s_cbranch_scc0 Lw_1
    s_endpgm
Ld_2:
    s_mov_b32 m0, 32768
    s_mov_b32 s60, 40960
L_gw2pB:
    buffer_load_dwordx4 v10, s[20:23], s56 offen offset:0 nt lds
    buffer_load_dwordx4 v11, s[20:23], s56 offen offset:1024 nt lds
    buffer_load_dwordx4 v12, s[20:23], s56 offen offset:2048 nt lds
    buffer_load_dwordx4 v13, s[20:23], s56 offen offset:3072 nt lds
    s_addk_i32 m0, 4096
    s_add_u32 s56, s56, 36864
    v_add_u32 v18, 4, v18
    s_waitcnt vmcnt(20)
    ds_max_i32 v17, v18 offset:27264
    s_cmp_lt_u32 m0, s60
    s_cbranch_scc1 L_gw2pB
    v_add_u32 v18, 4, v18
    s_waitcnt vmcnt(16)
    ds_max_i32 v17, v18 offset:27264
    v_add_u32 v18, 4, v18
    s_waitcnt vmcnt(12)
    ds_max_i32 v17, v18 offset:27264
    v_add_u32 v18, 4, v18
    s_waitcnt vmcnt(8)
    ds_max_i32 v17, v18 offset:27264
    v_add_u32 v18, -32, v18
    s_mov_b32 m0, 40960
    s_mov_b32 s60, 81920
    s_cmp_eq_u32 s8, 8
    s_cselect_b32 s60, 69632, s60
L_gw2B:
    buffer_load_dwordx4 v10, s[20:23], s56 offen offset:0 nt lds
    buffer_load_dwordx4 v11, s[20:23], s56 offen offset:1024 nt lds
    buffer_load_dwordx4 v12, s[20:23], s56 offen offset:2048 nt lds
    buffer_load_dwordx4 v13, s[20:23], s56 offen offset:3072 nt lds
    s_addk_i32 m0, 4096
    s_add_u32 s56, s56, 36864
    v_add_u32 v18, 4, v18
    s_waitcnt vmcnt(40)
    ds_max_i32 v17, v18 offset:27264
    s_cmp_lt_u32 m0, s60
    s_cbranch_scc1 L_gw2B
    v_add_u32 v18, 4, v18
    s_waitcnt vmcnt(36)
    ds_max_i32 v17, v18 offset:27264
    v_add_u32 v18, 4, v18
    s_waitcnt vmcnt(32)
    ds_max_i32 v17, v18 offset:27264
    v_add_u32 v18, 4, v18
    s_waitcnt vmcnt(28)
    ds_max_i32 v17, v18 offset:27264
    v_add_u32 v18, 4, v18
    s_waitcnt vmcnt(24)
    ds_max_i32 v17, v18 offset:27264
    v_add_u32 v18, 4, v18
    s_waitcnt vmcnt(20)
    ds_max_i32 v17, v18 offset:27264
    v_add_u32 v18, 4, v18
    s_waitcnt vmcnt(16)
    ds_max_i32 v17, v18 offset:27264
    v_add_u32 v18, 4, v18
    s_waitcnt vmcnt(12)
    ds_max_i32 v17, v18 offset:27264
    v_add_u32 v18, 4, v18
    s_waitcnt vmcnt(8)
    ds_max_i32 v17, v18 offset:27264
    v_add_u32 v18, 4, v18
    s_waitcnt vmcnt(4)
    ds_max_i32 v17, v18 offset:27264
    v_add_u32 v18, 4, v18
    s_waitcnt vmcnt(0)
    ds_max_i32 v17, v18 offset:27264
    s_endpgm
L_ttN:
    v_add_u32 v18, -2, v18
    s_branch L_tailA
L_ldA:
    s_mov_b64 s[20:21], s[38:39]
    s_mov_b32 s38, 5308416
    s_mov_b32 s39, s19
    v_mul_u32_u24 v6, 9216, v19
    v_add_u32 v6, v6, v20
    v_add_u32 v7, 72704, v6
    v_add_u32 v8, 145408, v6
    v_add_u32 v9, 218112, v6
    s_lshr_b32 s61, s52, 1
    s_lshl_b32 s61, s61, 7
    s_bitcmp1_b32 s52, 0
    s_cselect_b32 s56, 2654208, 0
    s_add_u32 s56, s56, s61
    v_add_u32 v18, -32, v18
    s_mov_b32 m0, 126976
    s_mov_b32 s60, 163840
L_gw1:
    buffer_load_dwordx4 v6, s[36:39], s56 offen offset:0 nt lds
    buffer_load_dwordx4 v7, s[36:39], s56 offen offset:1024 nt lds
    buffer_load_dwordx4 v8, s[36:39], s56 offen offset:2048 nt lds
    buffer_load_dwordx4 v9, s[36:39], s56 offen offset:3072 nt lds
    s_addk_i32 m0, 4096
    s_add_u32 s56, s56, 294912
    v_add_u32 v18, 4, v18
    s_waitcnt vmcnt(32)
    ds_max_i32 v17, v18 offset:27264
    s_cmp_lt_u32 m0, s60
    s_cbranch_scc1 L_gw1
    v_add_u32 v18, 4, v18
    s_waitcnt vmcnt(28)
    ds_max_i32 v17, v18 offset:27264
    s_mov_b32 m0, 32768
    s_mov_b32 s60, 98304
L_gK1:
    buffer_load_dwordx4 v15, s[12:15], s62 offen offset:0 nt lds
    buffer_load_dwordx4 v15, s[12:15], s62 offen offset:1024 nt lds
    buffer_load_dwordx4 v16, s[12:15], s62 offen offset:2048 nt lds
    buffer_load_dwordx4 v16, s[12:15], s62 offen offset:3072 nt lds
    s_addk_i32 m0, 4096
    s_addk_i32 s62, 4096
    s_pack_lh_b32_b16 s62, s62, s58
    v_add_u32 v18, 4, v18
    s_waitcnt vmcnt(28)
    ds_max_i32 v17, v18 offset:27264
    s_cmp_lt_u32 m0, s60
    s_cbranch_scc1 L_gK1
    v_mul_u32_u24 v10, 1152, v19
    v_add_u32 v10, v10, v20
    v_add_u32 v11, 8192, v10
    v_add_u32 v12, 16384, v10
    v_add_u32 v13, 24576, v10
    s_mov_b32 s30, s14
    s_mov_b32 s31, s19
    s_lshl_b32 s57, s8, 7
    s_mov_b32 s34, 4718592
    s_mov_b32 s35, s19
    s_mov_b32 s22, 5308416
    s_mov_b32 s23, s19
    s_mul_i32 s56, s4, 294912
    s_mul_i32 s59, s10, 36864
    s_cmp_lt_u32 s5, 9
    s_cselect_b32 s56, s56, s59
    s_add_u32 s56, s56, s57
Lw_3:
    ds_read_b32 v21, v17 offset:27520
    s_waitcnt lgkmcnt(0)
    v_readfirstlane_b32 s61, v21
    s_cmp_ge_i32 s61, 4
    s_cbranch_scc1 Ld_4
    s_sub_u32 s63, s63, 1
    s_cbranch_scc0 Lw_3
    s_endpgm
Ld_4:
    s_mov_b32 m0, 98304
    s_mov_b32 s60, 163840
L_gV:
    buffer_load_dwordx4 v15, s[28:31], s62 offen offset:0 nt lds
    buffer_load_dwordx4 v15, s[28:31], s62 offen offset:1024 nt lds
    buffer_load_dwordx4 v16, s[28:31], s62 offen offset:2048 nt lds
    buffer_load_dwordx4 v16, s[28:31], s62 offen offset:3072 nt lds
    s_addk_i32 m0, 4096
    s_addk_i32 s62, 4096
    s_pack_lh_b32_b16 s62, s62, s58
    v_add_u32 v18, 4, v18
    s_waitcnt vmcnt(28)
    ds_max_i32 v17, v18 offset:27264
    s_cmp_lt_u32 m0, s60
    s_cbranch_scc1 L_gV
    s_cmp_lt_u32 s5, 9
    s_cbranch_scc0 L_ttH
    v_add_u32 v18, 4, v18
    s_waitcnt vmcnt(24)
    ds_max_i32 v17, v18 offset:27264
L_tailA:
Lw_5:
    ds_read_b32 v21, v17 offset:27524
    s_waitcnt lgkmcnt(0)
    v_readfirstlane_b32 s61, v21
    s_cmp_ge_i32 s61, 4
    s_cbranch_scc1 Ld_6
    s_sub_u32 s63, s63, 1
    s_cbranch_scc0 Lw_5
    s_endpgm
Ld_6:
    s_mov_b32 m0, 32768
    s_mov_b32 s60, 40960
L_gwopA:
    buffer_load_dwordx4 v10, s[32:35], s56 offen offset:0 nt lds
    buffer_load_dwordx4 v11, s[32:35], s56 offen offset:1024 nt lds
    buffer_load_dwordx4 v12, s[32:35], s56 offen offset:2048 nt lds
    buffer_load_dwordx4 v13, s[32:35], s56 offen offset:3072 nt lds
    s_addk_i32 m0, 4096
    s_add_u32 s56, s56, 73728
    v_add_u32 v18, 4, v18
    s_waitcnt vmcnt(24)
    ds_max_i32 v17, v18 offset:27264
    s_cmp_lt_u32 m0, s60
    s_cbranch_scc1 L_gwopA
    v_add_u32 v18, 4, v18
    s_waitcnt vmcnt(20)
    ds_max_i32 v17, v18 offset:27264
    v_add_u32 v18, 4, v18
    s_waitcnt vmcnt(16)
    ds_max_i32 v17, v18 offset:27264
    v_add_u32 v18, 4, v18
    s_waitcnt vmcnt(12)
    ds_max_i32 v17, v18 offset:27264
    v_add_u32 v18, 4, v18
    s_waitcnt vmcnt(8)
    ds_max_i32 v17, v18 offset:27264
    v_add_u32 v18, -24, v18
    s_mov_b32 m0, 40960
    s_mov_b32 s60, 49152
L_gwo0A:
    buffer_load_dwordx4 v10, s[32:35], s56 offen offset:0 nt lds
    buffer_load_dwordx4 v11, s[32:35], s56 offen offset:1024 nt lds
    buffer_load_dwordx4 v12, s[32:35], s56 offen offset:2048 nt lds
    buffer_load_dwordx4 v13, s[32:35], s56 offen offset:3072 nt lds
    s_addk_i32 m0, 4096
    s_add_u32 s56, s56, 73728
    v_add_u32 v18, 4, v18
    s_waitcnt vmcnt(32)
    ds_max_i32 v17, v18 offset:27264
    s_cmp_lt_u32 m0, s60
    s_cbranch_scc1 L_gwo0A
    s_sub_u32 s56, s56, 258048
    s_mov_b32 m0, 49152
    s_mov_b32 s60, 65536
L_gwo1A:
    buffer_load_dwordx4 v10, s[32:35], s56 offen offset:0 nt lds
    buffer_load_dwordx4 v11, s[32:35], s56 offen offset:1024 nt lds
    buffer_load_dwordx4 v12, s[32:35], s56 offen offset:2048 nt lds
    buffer_load_dwordx4 v13, s[32:35], s56 offen offset:3072 nt lds
    s_addk_i32 m0, 4096
    s_add_u32 s56, s56, 73728
    v_add_u32 v18, 4, v18
    s_waitcnt vmcnt(32)
    ds_max_i32 v17, v18 offset:27264
    s_cmp_lt_u32 m0, s60
    s_cbranch_scc1 L_gwo1A
    v_add_u32 v18, 4, v18
    s_waitcnt vmcnt(28)
    ds_max_i32 v17, v18 offset:27264
    v_add_u32 v18, 4, v18
    s_waitcnt vmcnt(24)
    ds_max_i32 v17, v18 offset:27264
    v_add_u32 v18, 4, v18
    s_waitcnt vmcnt(20)
    ds_max_i32 v17, v18 offset:27264
    v_add_u32 v18, 4, v18
    s_waitcnt vmcnt(16)
    ds_max_i32 v17, v18 offset:27264
    v_add_u32 v18, 4, v18
    s_waitcnt vmcnt(12)
    ds_max_i32 v17, v18 offset:27264
    v_add_u32 v18, 4, v18
    s_waitcnt vmcnt(8)
    ds_max_i32 v17, v18 offset:27264
    v_add_u32 v18, 4, v18
    s_waitcnt vmcnt(4)
    ds_max_i32 v17, v18 offset:27264
    v_add_u32 v18, 4, v18
    s_waitcnt vmcnt(0)
    ds_max_i32 v17, v18 offset:27264
    s_endpgm
L_ttH:
    v_add_u32 v18, 4, v18
    s_waitcnt vmcnt(24)
    ds_max_i32 v17, v18 offset:27264
    v_add_u32 v18, 4, v18
    s_waitcnt vmcnt(20)
    ds_max_i32 v17, v18 offset:27264
    s_branch L_tailB
L_comp:
    v_lshrrev_b32 v2, 4, v1
    v_and_b32 v3, 15, v1
    v_mov_b32 v20, 27264
    s_mov_b64 s[40:41], s[50:51]
    s_mov_b64 s[48:49], s[46:47]
    s_mov_b32 s42, 0x10000000
    s_mov_b32 s43, s19
    v_and_b32 v36, 1, v1
    v_lshlrev_b32 v24, 8, v2
    v_lshl_add_u32 v24, v36, 12, v24
    s_lshl_b32 s25, s4, 13
    s_lshl_b32 s56, s3, 10
    s_add_u32 s56, s56, s25
    s_lshl4_add_u32 s25, s5, s56
    s_add_u32 s25, s25, 1048576
    v_mov_b32 v204, -1
    v_mov_b32 v205, -1
    v_mov_b32 v206, -1
    v_mov_b32 v207, -1
    s_mov_b32 s26, 0x00030003
    s_mov_b32 s27, s26
    s_mov_b64 exec, s[26:27]
    buffer_store_dwordx4 v[204:207], v24, s[40:43], s25 offen
    s_mov_b64 exec, -1
    v_lshlrev_b32 v21, 4, v1
    v_bfe_u32 v32, v1, 2, 2
    v_and_b32 v33, 3, v1
    v_lshrrev_b32 v34, 1, v33
    v_and_b32 v35, 1, v33
    v_lshlrev_b32 v35, 3, v35
    v_lshl_add_u32 v38, v2, 2, v32
    v_and_b32 v37, 6, v38
    v_xor_b32 v37, v37, v34
    v_lshlrev_b32 v4, 7, v38
    v_lshl_add_u32 v4, v37, 4, v4
    v_add_u32 v4, v4, v35
    s_lshl_b32 s56, s3, 5
    v_xor_b32 v8, s56, v4
    v_add_u32 v9, 126976, v8
    s_lshl_b32 s56, s3, 12
    s_add_u32 s56, s56, 32768
    v_add_u32 v4, s56, v4
    v_xor_b32 v5, 32, v4
    v_xor_b32 v6, 64, v4
    v_xor_b32 v7, 0x60, v4
    v_lshl_add_u32 v39, v2, 3, v32
    v_and_b32 v37, 1, v2
    v_lshl_add_u32 v37, v37, 2, v32
    v_lshlrev_b32 v37, 1, v37
    s_lshl_b32 s56, s3, 2
    v_add_u32 v36, s56, v34
    v_xor_b32 v36, v36, v37
    v_lshlrev_b32 v16, 8, v39
    v_lshl_add_u32 v16, v36, 4, v16
    v_add_u32 v16, v16, v35
    v_add_u32 v16, 98304, v16
    v_xor_b32 v17, 32, v16
    v_mul_u32_u24 v36, 1152, v33
    v_add_u32 v19, 18432, v36
    s_mul_i32 s56, s7, 288
    v_lshl_add_u32 v10, v2, 3, v19
    s_bitcmp1_b32 s52, 0
    s_cselect_b32 s57, 576, 0
    v_add_u32 v41, s57, v10
    v_add_u32 v10, s56, v10
    v_lshrrev_b32 v36, 3, v3
    v_lshl_add_u32 v36, v36, 2, v33
    v_lshlrev_b32 v36, 1, v36
    v_xor_b32 v36, v36, v2
    v_lshlrev_b32 v36, 4, v36
    s_lshl_b32 s56, s3, 14
    s_add_u32 s56, s56, 32768
    v_lshl_add_u32 v11, v3, 8, v36
    v_add_u32 v11, s56, v11
    v_xor_b32 v12, 64, v11
    v_xor_b32 v13, 128, v11
    v_xor_b32 v14, 192, v11
    v_and_b32 v36, 1, v1
    v_lshlrev_b32 v37, 4, v2
    v_lshl_add_u32 v15, v36, 8, v37
    v_lshl_add_u32 v18, v36, 9, v37
    s_lshl_b32 s56, s3, 6
    v_add_u32 v38, s56, v37
    v_lshl_add_u32 v22, v3, 12, v38
    v_lshl_add_u32 v23, v3, 6, v37
    s_lshl_b32 s56, s3, 7
    v_lshlrev_b32 v26, 9, v36
    v_lshl_add_u32 v26, v2, 3, v26
    v_add_u32 v26, s56, v26
    v_lshlrev_b32 v27, 3, v36
    v_lshlrev_b32 v50, 2, v1
    v_lshlrev_b32 v51, 4, v33
    v_lshl_add_u32 v51, v2, 6, v51
    v_lshl_add_u32 v52, v36, 10, v37
    v_lshl_add_u32 v52, v32, 6, v52
    v_lshl_add_u32 v52, v34, 8, v52
    v_lshlrev_b32 v54, 10, v36
    v_lshl_add_u32 v54, v34, 14, v54
    s_lshl_b32 s56, s3, 10
    s_add_u32 s56, s56, 28672
    v_lshlrev_b32 v53, 8, v2
    v_lshl_add_u32 v53, v3, 2, v53
    v_add_u32 v53, s56, v53
    s_getreg_b32 s24, hwreg(HW_REG_XCC_ID, 0, 3)
    s_movk_i32 s46, 1152
    s_mov_b32 s47, s19
    s_movk_i32 s50, 4608
    s_mov_b32 s51, s19
    s_lshl_b32 s24, s24, 8
    s_waitcnt lgkmcnt(0)
    s_mov_b32 s17, s53
    s_add_u32 s11, s11, 0x01010101
    s_and_b32 s12, s11, 0xff
    s_bfe_u32 s13, s11, 0x80008
    s_bfe_u32 s14, s11, 0x80010
    s_lshr_b32 s15, s11, 24
    s_or_b32 s24, s24, s12
    s_mov_b32 s16, 0xffffff00
    s_movk_i32 s20, 0xf800
    v_mov_b32 v28, s12
    v_mov_b32 v29, s13
    v_mov_b32 v30, s14
    v_mov_b32 v31, s15
    v_mov_b32 v45, s24
    s_mov_b32 s18, 0x000f000f
    s_mov_b32 s19, s18
    v_mov_b32 v40, 1
    s_sub_u32 s96, s2, 220
    s_cselect_b32 s97, 1, s3
    s_cmp_eq_u32 s97, 0
    s_cbranch_scc0 L_nogw
    s_mov_b32 m0, 23552
    s_nop 0
    buffer_load_dwordx4 v21, s[44:47], 0 offen lds
    buffer_load_dwordx4 v21, s[44:47], 0 offen offset:1024 lds
L_nogw:
    s_lshl_b32 s22, s4, 14
    s_add_u32 s22, s22, 65536
    s_lshl_b32 s56, s7, 10
    s_lshl_b32 s57, s6, 8
    s_add_u32 s56, s56, s57
    s_add_u32 s56, s56, s22
    s_add_u32 s99, s56, 2097152
Lw_7:
    ds_read_b32 v32, v20 offset:0
    s_waitcnt lgkmcnt(0)
    v_readfirstlane_b32 s61, v32
    s_cmp_ge_i32 s61, 24
    s_cbranch_scc1 Ld_8
    s_sub_u32 s63, s63, 1
    s_cbranch_scc0 Lw_7
    s_endpgm
Ld_8:
    ds_read2_b64 v[128:131], v10 offset0:0 offset1:4
    ds_read2_b64 v[132:135], v10 offset0:8 offset1:12
    ds_read2_b64 v[136:139], v10 offset0:16 offset1:20
    ds_read2_b64 v[140:143], v10 offset0:24 offset1:28
    ds_read_b64_tr_b16 v[64:65], v8 offset:0
    ds_read_b64_tr_b16 v[66:67], v8 offset:2048
    ds_read_b64_tr_b16 v[68:69], v8 offset:4096
    ds_read_b64_tr_b16 v[70:71], v8 offset:6144
    ds_read_b64_tr_b16 v[72:73], v8 offset:8192
    ds_read_b64_tr_b16 v[74:75], v8 offset:10240
    ds_read_b64_tr_b16 v[76:77], v8 offset:12288
    ds_read_b64_tr_b16 v[78:79], v8 offset:14336
    ds_read_b64 v[144:145], v10 offset:256
    ds_read_b64_tr_b16 v[80:81], v8 offset:16384
    s_waitcnt lgkmcnt(0)
    v_mfma_f32_16x16x32_bf16 v[176:179], v[64:67], v[128:131], 0
    v_mfma_f32_16x16x32_bf16 v[176:179], v[68:71], v[132:135], v[176:179]
    v_mfma_f32_16x16x32_bf16 v[176:179], v[72:75], v[136:139], v[176:179]
    v_mfma_f32_16x16x32_bf16 v[176:179], v[76:79], v[140:143], v[176:179]
    s_nop 7
    v_mfma_f32_16x16x16_bf16 v[176:179], v[80:81], v[144:145], v[176:179]
    s_nop 7
    v_and_or_b32 v176, v176, s20, v45
    v_and_or_b32 v177, v177, s16, v29
    v_and_or_b32 v178, v178, s16, v30
    v_and_or_b32 v179, v179, s16, v31
    s_mov_b64 exec, s[18:19]
    buffer_store_dwordx4 v[176:179], v22, s[40:43], s56 offen
    s_mov_b64 exec, -1
    s_cmp_lg_u32 s17, 24
    s_cbranch_scc0 L_noh
    s_lshl2_add_u32 s56, s52, s3
    s_lshl_b32 s56, s56, 8
    s_add_u32 s100, s56, 393216
    ds_read2_b64 v[128:131], v41 offset0:0 offset1:4
    ds_read2_b64 v[132:135], v41 offset0:8 offset1:12
    ds_read2_b64 v[136:139], v41 offset0:16 offset1:20
    ds_read2_b64 v[140:143], v41 offset0:24 offset1:28
    ds_read2_b64 v[144:147], v41 offset0:32 offset1:36
    ds_read2_b64 v[148:151], v41 offset0:40 offset1:44
    ds_read2_b64 v[152:155], v41 offset0:48 offset1:52
    ds_read2_b64 v[156:159], v41 offset0:56 offset1:60
    ds_read2_b64 v[160:163], v41 offset0:64 offset1:68
Lw_9:
    ds_read_b32 v32, v20 offset:0
    s_waitcnt lgkmcnt(0)
    v_readfirstlane_b32 s61, v32
    s_cmp_ge_i32 s61, 60
    s_cbranch_scc1 Ld_10
    s_sub_u32 s63, s63, 1
    s_cbranch_scc0 Lw_9
    s_endpgm
Ld_10:
    ds_read_b64_tr_b16 v[64:65], v9 offset:0
    ds_read_b64_tr_b16 v[66:67], v9 offset:2048
    ds_read_b64_tr_b16 v[68:69], v9 offset:4096
    ds_read_b64_tr_b16 v[70:71], v9 offset:6144
    ds_read_b64_tr_b16 v[72:73], v9 offset:8192
    ds_read_b64_tr_b16 v[74:75], v9 offset:10240
    ds_read_b64_tr_b16 v[76:77], v9 offset:12288
    ds_read_b64_tr_b16 v[78:79], v9 offset:14336
    ds_read_b64_tr_b16 v[80:81], v9 offset:16384
    ds_read_b64_tr_b16 v[82:83], v9 offset:18432
    ds_read_b64_tr_b16 v[84:85], v9 offset:20480
    ds_read_b64_tr_b16 v[86:87], v9 offset:22528
    ds_read_b64_tr_b16 v[88:89], v9 offset:24576
    ds_read_b64_tr_b16 v[90:91], v9 offset:26624
    ds_read_b64_tr_b16 v[92:93], v9 offset:28672
    ds_read_b64_tr_b16 v[94:95], v9 offset:30720
    ds_read_b64_tr_b16 v[96:97], v9 offset:32768
    ds_read_b64_tr_b16 v[98:99], v9 offset:34816
    s_mov_b64 exec, 1
    ds_add_u32 v20, v40 offset:256
    s_mov_b64 exec, -1
    s_waitcnt lgkmcnt(15)
    v_mfma_f32_16x16x32_bf16 v[180:183], v[64:67], v[128:131], 0
    s_waitcnt lgkmcnt(15)
    v_mfma_f32_16x16x32_bf16 v[180:183], v[68:71], v[132:135], v[180:183]
    s_waitcnt lgkmcnt(13)
    v_mfma_f32_16x16x32_bf16 v[180:183], v[72:75], v[136:139], v[180:183]
    s_waitcnt lgkmcnt(11)
    v_mfma_f32_16x16x32_bf16 v[180:183], v[76:79], v[140:143], v[180:183]
    s_waitcnt lgkmcnt(9)
    v_mfma_f32_16x16x32_bf16 v[180:183], v[80:83], v[144:147], v[180:183]
    s_waitcnt lgkmcnt(7)
    v_mfma_f32_16x16x32_bf16 v[180:183], v[84:87], v[148:151], v[180:183]
    s_waitcnt lgkmcnt(5)
    v_mfma_f32_16x16x32_bf16 v[180:183], v[88:91], v[152:155], v[180:183]
    s_waitcnt lgkmcnt(3)
    v_mfma_f32_16x16x32_bf16 v[180:183], v[92:95], v[156:159], v[180:183]
    s_waitcnt lgkmcnt(1)
    v_mfma_f32_16x16x32_bf16 v[180:183], v[96:99], v[160:163], v[180:183]
    s_nop 7
    v_and_or_b32 v180, v180, s16, v28
    v_and_or_b32 v181, v181, s16, v29
    v_and_or_b32 v182, v182, s16, v30
    v_and_or_b32 v183, v183, s16, v31
    s_cmp_eq_u32 s3, 3
    s_cbranch_scc1 L_noh
    s_mov_b64 exec, s[18:19]
    buffer_store_dwordx4 v[180:183], v23, s[40:43], s100 offen sc1
    s_mov_b64 exec, -1
L_noh:
    s_cmp_eq_u32 s97, 0
    s_cbranch_scc0 L_nogate
    v_lshlrev_b32 v32, 4, v2
    v_add_u32 v33, v19, v32
    s_waitcnt vmcnt(1)
    ds_read_b128 v[64:67], v32 offset:23552
    ds_read_b128 v[128:131], v33 offset:0
    ds_read_b128 v[68:71], v32 offset:23616
    ds_read_b128 v[132:135], v33 offset:64
    ds_read_b128 v[72:75], v32 offset:23680
    ds_read_b128 v[136:139], v33 offset:128
    ds_read_b128 v[76:79], v32 offset:23744
    ds_read_b128 v[140:143], v33 offset:192
    ds_read_b128 v[80:83], v32 offset:23808
    ds_read_b128 v[144:147], v33 offset:256
    ds_read_b128 v[84:87], v32 offset:23872
    ds_read_b128 v[148:151], v33 offset:320
    ds_read_b128 v[88:91], v32 offset:23936
    ds_read_b128 v[152:155], v33 offset:384
    ds_read_b128 v[92:95], v32 offset:24000
    ds_read_b128 v[156:159], v33 offset:448
    ds_read_b128 v[96:99], v32 offset:24064
    ds_read_b128 v[160:163], v33 offset:512
    s_waitcnt lgkmcnt(0)
    v_mfma_f32_16x16x32_bf16 v[180:183], v[64:67], v[128:131], 0
    v_mfma_f32_16x16x32_bf16 v[180:183], v[68:71], v[132:135], v[180:183]
    v_mfma_f32_16x16x32_bf16 v[180:183], v[72:75], v[136:139], v[180:183]
    v_mfma_f32_16x16x32_bf16 v[180:183], v[76:79], v[140:143], v[180:183]
    v_mfma_f32_16x16x32_bf16 v[180:183], v[80:83], v[144:147], v[180:183]
    v_mfma_f32_16x16x32_bf16 v[180:183], v[84:87], v[148:151], v[180:183]
    v_mfma_f32_16x16x32_bf16 v[180:183], v[88:91], v[152:155], v[180:183]
    v_mfma_f32_16x16x32_bf16 v[180:183], v[92:95], v[156:159], v[180:183]
    v_mfma_f32_16x16x32_bf16 v[180:183], v[96:99], v[160:163], v[180:183]
    ds_read_b128 v[64:67], v32 offset:24128
    ds_read_b128 v[128:131], v33 offset:576
    ds_read_b128 v[68:71], v32 offset:24192
    ds_read_b128 v[132:135], v33 offset:640
    ds_read_b128 v[72:75], v32 offset:24256
    ds_read_b128 v[136:139], v33 offset:704
    ds_read_b128 v[76:79], v32 offset:24320
    ds_read_b128 v[140:143], v33 offset:768
    ds_read_b128 v[80:83], v32 offset:24384
    ds_read_b128 v[144:147], v33 offset:832
    ds_read_b128 v[84:87], v32 offset:24448
    ds_read_b128 v[148:151], v33 offset:896
    ds_read_b128 v[88:91], v32 offset:24512
    ds_read_b128 v[152:155], v33 offset:960
    ds_read_b128 v[92:95], v32 offset:24576
    ds_read_b128 v[156:159], v33 offset:1024
    ds_read_b128 v[96:99], v32 offset:24640
    ds_read_b128 v[160:163], v33 offset:1088
    s_waitcnt lgkmcnt(0)
    v_mfma_f32_16x16x32_bf16 v[180:183], v[64:67], v[128:131], v[180:183]
    v_mfma_f32_16x16x32_bf16 v[180:183], v[68:71], v[132:135], v[180:183]
    v_mfma_f32_16x16x32_bf16 v[180:183], v[72:75], v[136:139], v[180:183]
    v_mfma_f32_16x16x32_bf16 v[180:183], v[76:79], v[140:143], v[180:183]
    v_mfma_f32_16x16x32_bf16 v[180:183], v[80:83], v[144:147], v[180:183]
    v_mfma_f32_16x16x32_bf16 v[180:183], v[84:87], v[148:151], v[180:183]
    v_mfma_f32_16x16x32_bf16 v[180:183], v[88:91], v[152:155], v[180:183]
    v_mfma_f32_16x16x32_bf16 v[180:183], v[92:95], v[156:159], v[180:183]
    v_mfma_f32_16x16x32_bf16 v[180:183], v[96:99], v[160:163], v[180:183]
    s_nop 7
    v_mul_f32 v44, 0xbfb8aa3b, v180
    v_exp_f32 v44, v44
    s_nop 0
    v_add_f32 v44, 1.0, v44
    v_rcp_f32 v44, v44
    s_mov_b64 exec, 15
    ds_write_b32 v50, v44 offset:27536
    s_mov_b64 exec, -1
    s_cmp_eq_u32 s97, 0
    s_cbranch_scc0 L_ft2
    s_and_b32 s58, s2, 7
    s_sub_u32 s57, s96, 4
    s_cselect_b32 s58, 8, s58
    s_lshr_b32 s57, s57, 3
    s_min_u32 s57, s57, s96
    s_lshl_b32 s58, s58, 15
    s_lshl_b32 s57, s57, 8
    s_add_u32 s58, s58, s57
    s_add_u32 s58, s58, 1572864
    v_lshrrev_b32 v56, 1, v1
    v_and_b32 v57, 1, v1
    v_lshlrev_b32 v56, 10, v56
    v_lshl_add_u32 v56, v57, 7, v56
    buffer_load_dword v57, v56, s[40:43], s58 offen sc1
L_ft2:
L_nogate:
    s_cmp_eq_u32 s3, 3
    s_cbranch_scc0 L_noq
    s_lshl_b32 s56, s6, 12
    s_add_u32 s56, s56, s22
    s_movk_i32 s57, 0x7ff
    s_movk_i32 s58, 24
L_qpoll:
    buffer_load_dwordx4 v[208:211], v21, s[40:43], s56 offen offset:0 sc1
    buffer_load_dwordx4 v[212:215], v21, s[40:43], s56 offen offset:1024 sc1
    buffer_load_dwordx4 v[216:219], v21, s[40:43], s56 offen offset:2048 sc1
    buffer_load_dwordx4 v[220:223], v21, s[40:43], s56 offen offset:3072 sc1
    s_waitcnt vmcnt(3)
    v_xor_b32 v208, s24, v208
    v_xor_b32 v209, s13, v209
    v_xor_b32 v210, s14, v210
    v_xor_b32 v211, s15, v211
    v_or3_b32 v32, v209, v210, v211
    s_waitcnt vmcnt(2)
    v_xor_b32 v212, s24, v212
    v_xor_b32 v213, s13, v213
    v_xor_b32 v214, s14, v214
    v_xor_b32 v215, s15, v215
    v_or3_b32 v32, v32, v213, v214
    v_or_b32 v32, v32, v215
    s_waitcnt vmcnt(1)
    v_xor_b32 v216, s24, v216
    v_xor_b32 v217, s13, v217
    v_xor_b32 v218, s14, v218
    v_xor_b32 v219, s15, v219
    v_or3_b32 v32, v32, v217, v218
    v_or_b32 v32, v32, v219
    s_waitcnt vmcnt(0)
    v_xor_b32 v220, s24, v220
    v_xor_b32 v221, s13, v221
    v_xor_b32 v222, s14, v222
    v_xor_b32 v223, s15, v223
    v_or3_b32 v32, v32, v221, v222
    v_or_b32 v32, v32, v223
    v_or3_b32 v33, v208, v212, v216
    v_or_b32 v33, v33, v220
    v_and_b32 v32, 0xff, v32
    v_and_or_b32 v32, v33, s57, v32
    v_cmp_ne_u32 vcc, 0, v32
    s_cbranch_vccz L_qok
    s_sub_u32 s58, s58, 1
    s_cmp_eq_u32 s58, 0
    s_cbranch_scc1 L_qto
L_qcont:
    s_sub_u32 s63, s63, 1
    s_cbranch_scc0 L_qpoll
    s_endpgm
L_qok:
    v_and_b32 v33, 0x700, v33
    v_cmp_ne_u32 vcc, 0, v33
    v_and_b32 v208, s20, v208
    v_and_b32 v212, s20, v212
    v_and_b32 v216, s20, v216
    v_and_b32 v220, s20, v220
    s_cmp_eq_u64 vcc, 0
    s_cselect_b32 s56, 1, 2
    v_add_f32 v208, v208, v212
    v_add_f32 v216, v216, v220
    v_add_f32 v209, v209, v213
    v_add_f32 v217, v217, v221
    v_add_f32 v210, v210, v214
    v_add_f32 v218, v218, v222
    v_add_f32 v211, v211, v215
    v_add_f32 v219, v219, v223
    v_add_f32 v208, v208, v216
    v_add_f32 v209, v209, v217
    v_add_f32 v210, v210, v218
    v_add_f32 v211, v211, v219
    v_cvt_pk_bf16_f32 v208, v208, v209
    v_cvt_pk_bf16_f32 v209, v210, v211
    v_lshlrev_b32 v32, 3, v1
    v_mov_b32 v33, s56
    ds_write_b64 v32, v[208:209] offset:25600
    ds_write_b32 v20, v33 offset:268
    s_mov_b64 exec, s[18:19]
    s_cmp_lg_u32 s17, 24
    s_cbranch_scc0 L_q3b
    buffer_store_dwordx4 v[180:183], v23, s[40:43], s100 offen sc1
L_q3b:
    s_mov_b64 exec, -1
L_noq:
    s_lshl_b32 s56, s3, 4
    s_add_u32 s56, s56, s17
    s_add_u32 s56, s56, 16
Lw_11:
    ds_read_b32 v32, v20 offset:0
    s_waitcnt lgkmcnt(0)
    v_readfirstlane_b32 s61, v32
    s_cmp_ge_i32 s61, s56
    s_cbranch_scc1 Ld_12
    s_sub_u32 s63, s63, 1
    s_cbranch_scc0 Lw_11
    s_endpgm
Ld_12:
    ds_read_b128 v[64:67], v11 offset:0
    ds_read_b128 v[68:71], v12 offset:0
    ds_read_b128 v[72:75], v13 offset:0
    ds_read_b128 v[76:79], v14 offset:0
    ds_read_b128 v[80:83], v11 offset:4096
    ds_read_b128 v[84:87], v12 offset:4096
    ds_read_b128 v[88:91], v13 offset:4096
    ds_read_b128 v[92:95], v14 offset:4096
    ds_read_b128 v[96:99], v11 offset:8192
    ds_read_b128 v[100:103], v12 offset:8192
    ds_read_b128 v[104:107], v13 offset:8192
    ds_read_b128 v[108:111], v14 offset:8192
    ds_read_b128 v[112:115], v11 offset:12288
    ds_read_b128 v[116:119], v12 offset:12288
    ds_read_b128 v[120:123], v13 offset:12288
    ds_read_b128 v[124:127], v14 offset:12288
    s_mov_b64 exec, 1
    ds_add_u32 v20, v40 offset:260
    s_mov_b64 exec, -1
Lw_13:
    ds_read_b32 v32, v20 offset:268
    s_waitcnt lgkmcnt(0)
    v_readfirstlane_b32 s61, v32
    s_cmp_ge_i32 s61, 1
    s_cbranch_scc1 Ld_14
    s_sub_u32 s63, s63, 1
    s_cbranch_scc0 Lw_13
    s_endpgm
Ld_14:
    s_mov_b32 s98, s61
    ds_read_b128 v[128:131], v15 offset:25600
    ds_read_b128 v[132:135], v15 offset:25664
    ds_read_b128 v[136:139], v15 offset:25728
    ds_read_b128 v[140:143], v15 offset:25792
    s_waitcnt lgkmcnt(0)
    v_mfma_f32_16x16x32_bf16 v[176:179], v[64:67], v[128:131], 0
    v_mfma_f32_16x16x32_bf16 v[180:183], v[80:83], v[128:131], 0
    v_mfma_f32_16x16x32_bf16 v[184:187], v[96:99], v[128:131], 0
    v_mfma_f32_16x16x32_bf16 v[188:191], v[112:115], v[128:131], 0
    v_mfma_f32_16x16x32_bf16 v[176:179], v[68:71], v[132:135], v[176:179]
    v_mfma_f32_16x16x32_bf16 v[180:183], v[84:87], v[132:135], v[180:183]
    v_mfma_f32_16x16x32_bf16 v[184:187], v[100:103], v[132:135], v[184:187]
    v_mfma_f32_16x16x32_bf16 v[188:191], v[116:119], v[132:135], v[188:191]
    v_mfma_f32_16x16x32_bf16 v[176:179], v[72:75], v[136:139], v[176:179]
    v_mfma_f32_16x16x32_bf16 v[180:183], v[88:91], v[136:139], v[180:183]
    v_mfma_f32_16x16x32_bf16 v[184:187], v[104:107], v[136:139], v[184:187]
    v_mfma_f32_16x16x32_bf16 v[188:191], v[120:123], v[136:139], v[188:191]
    v_mfma_f32_16x16x32_bf16 v[176:179], v[76:79], v[140:143], v[176:179]
    v_mfma_f32_16x16x32_bf16 v[180:183], v[92:95], v[140:143], v[180:183]
    v_mfma_f32_16x16x32_bf16 v[184:187], v[108:111], v[140:143], v[184:187]
    v_mfma_f32_16x16x32_bf16 v[188:191], v[124:127], v[140:143], v[188:191]
    s_mov_b32 s24, 0x3e0293ee
    s_mov_b32 s21, 0
    s_cmp_eq_u32 s98, 1
    s_cbranch_scc0 L_rsent
L_rsentd:
    s_nop 0
    v_max3_f32 v32, v176, v177, v178
    v_max3_f32 v33, v179, v180, v181
    v_max3_f32 v32, v32, v182, v183
    v_max3_f32 v33, v33, v184, v185
    v_max3_f32 v32, v32, v186, v187
    v_max3_f32 v33, v33, v188, v189
    v_max3_f32 v32, v32, v190, v191
    v_max_f32 v32, v32, v33
    v_mov_b32 v33, v32
    s_nop 1
    v_permlane32_swap_b32 v32, v33
    v_max_f32 v32, v32, v33
    v_mov_b32 v33, v32
    s_nop 1
    v_permlane16_swap_b32 v32, v33
    v_max_f32 v32, v32, v33
    v_mul_f32 v32, s24, v32
    v_and_b32 v32, s16, v32
    v_fma_f32 v176, v176, s24, -v32
    v_fma_f32 v177, v177, s24, -v32
    v_fma_f32 v178, v178, s24, -v32
    v_fma_f32 v179, v179, s24, -v32
    v_fma_f32 v180, v180, s24, -v32
    v_fma_f32 v181, v181, s24, -v32
    v_fma_f32 v182, v182, s24, -v32
    v_fma_f32 v183, v183, s24, -v32
    v_fma_f32 v184, v184, s24, -v32
    v_fma_f32 v185, v185, s24, -v32
    v_fma_f32 v186, v186, s24, -v32
    v_fma_f32 v187, v187, s24, -v32
    v_fma_f32 v188, v188, s24, -v32
    v_fma_f32 v189, v189, s24, -v32
    v_fma_f32 v190, v190, s24, -v32
    v_fma_f32 v191, v191, s24, -v32
    v_exp_f32 v176, v176
    v_exp_f32 v177, v177
    v_exp_f32 v178, v178
    v_exp_f32 v179, v179
    v_exp_f32 v180, v180
    v_exp_f32 v181, v181
    v_exp_f32 v182, v182
    v_exp_f32 v183, v183
    v_exp_f32 v184, v184
    v_exp_f32 v185, v185
    v_exp_f32 v186, v186
    v_exp_f32 v187, v187
    v_exp_f32 v188, v188
    v_exp_f32 v189, v189
    v_exp_f32 v190, v190
    v_exp_f32 v191, v191
    v_cvt_pk_bf16_f32 v192, v176, v177
    v_cvt_pk_bf16_f32 v193, v178, v179
    v_cvt_pk_bf16_f32 v194, v180, v181
    v_cvt_pk_bf16_f32 v195, v182, v183
    v_cvt_pk_bf16_f32 v196, v184, v185
    v_cvt_pk_bf16_f32 v197, v186, v187
    v_cvt_pk_bf16_f32 v198, v188, v189
    v_cvt_pk_bf16_f32 v199, v190, v191
    v_add_f32 v176, v176, v184
    v_add_f32 v177, v177, v185
    v_add_f32 v178, v178, v186
    v_add_f32 v179, v179, v187
    v_add_f32 v180, v180, v188
    v_add_f32 v181, v181, v189
    v_add_f32 v182, v182, v190
    v_add_f32 v183, v183, v191
    v_add_f32 v176, v176, v180
    v_add_f32 v177, v177, v181
    v_add_f32 v178, v178, v182
    v_add_f32 v179, v179, v183
    v_add_f32 v176, v176, v177
    v_add_f32 v178, v178, v179
    v_add_f32 v33, v176, v178
    v_mov_b32 v34, v33
    s_nop 1
    v_permlane32_swap_b32 v33, v34
    v_add_f32 v33, v33, v34
    v_mov_b32 v34, v33
    s_nop 1
    v_permlane16_swap_b32 v33, v34
    v_add_f32 v33, v33, v34
    s_lshl_b32 s56, s3, 4
    v_add_u32 v34, s56, v27
    s_mov_b64 exec, s[26:27]
    ds_write_b64 v26, v[192:193] offset:26112
    ds_write_b64 v26, v[194:195] offset:26144
    ds_write_b64 v26, v[196:197] offset:26176
    ds_write_b64 v26, v[198:199] offset:26208
    ds_write_b64 v34, v[32:33] offset:27136
    s_mov_b64 exec, 1
    s_waitcnt vmcnt(1)
    ds_add_u32 v20, v40 offset:264
    s_mov_b64 exec, -1
    s_lshl_b32 s23, s4, 8
    s_add_u32 s23, s23, 1376256
    s_add_u32 s56, s10, s3
    s_and_b32 s57, s56, -2
    s_add_u32 s56, s56, s57
    s_lshl_b32 s56, s56, 9
    s_add_u32 s28, s56, 393216
    s_add_u32 s22, s28, 4096
    s_cmp_eq_u32 s8, 8
    s_cselect_b32 s101, s3, 0
    s_cselect_b32 s30, 36, 48
    s_add_u32 s30, s30, s17
    s_addk_i32 s30, 128
    s_add_u32 s54, s17, 144
    s_add_u32 s55, s17, 160
    s_cmp_eq_u32 s101, 0
    s_cselect_b32 s59, 4096, 0
    s_add_u32 s59, s59, s22
    s_lshl_b32 s29, s4, 13
    s_lshl_b32 s56, s3, 11
    s_add_u32 s29, s29, s56
    s_add_u32 s29, s29, s21
    s_add_u32 s29, s29, 1048576
    s_add_u32 s58, s9, 16
    s_cmp_lt_u32 s5, 9
    s_cselect_b32 s58, s4, s58
    s_lshl_b32 s31, s8, 5
    s_add_u32 s31, s31, s58
    s_lshl_b32 s31, s31, 10
    s_add_u32 s31, s31, 1572864
    s_lshl_b32 s32, s8, 15
    s_add_u32 s32, s32, 68352
    s_mov_b32 s33, 0
Lw_15:
    ds_read_b32 v32, v20 offset:264
    s_waitcnt lgkmcnt(0)
    v_readfirstlane_b32 s61, v32
    s_cmp_ge_i32 s61, 4
    s_cbranch_scc1 Ld_16
    s_sub_u32 s63, s63, 1
    s_cbranch_scc0 Lw_15
    s_endpgm
Ld_16:
    ds_read_b128 v[128:131], v18 offset:26112
    ds_read_b128 v[132:135], v18 offset:26176
    ds_read_b128 v[136:139], v18 offset:26240
    ds_read_b128 v[140:143], v18 offset:26304
    ds_read_b128 v[144:147], v18 offset:26368
    ds_read_b128 v[148:151], v18 offset:26432
    ds_read_b128 v[152:155], v18 offset:26496
    ds_read_b128 v[156:159], v18 offset:26560
    ds_read_b64 v[192:193], v27 offset:27136
    ds_read_b64 v[194:195], v27 offset:27152
    ds_read_b64 v[196:197], v27 offset:27168
    ds_read_b64 v[198:199], v27 offset:27184
    s_waitcnt lgkmcnt(0)
    v_max3_f32 v200, v192, v194, v196
    v_max_f32 v200, v200, v198
    v_sub_f32 v192, v192, v200
    v_sub_f32 v194, v194, v200
    v_sub_f32 v196, v196, v200
    v_sub_f32 v198, v198, v200
    v_exp_f32 v192, v192
    v_exp_f32 v194, v194
    v_exp_f32 v196, v196
    v_exp_f32 v198, v198
    v_mul_f32 v201, v192, v193
    v_fmac_f32 v201, v194, v195
    v_fmac_f32 v201, v196, v197
    v_fmac_f32 v201, v198, v199
    v_mov_b32_dpp v202, v200 quad_perm:[1,1,1,1] row_mask:0xf bank_mask:0xf
    s_nop 0
    v_mov_b32_dpp v203, v201 quad_perm:[1,1,1,1] row_mask:0xf bank_mask:0xf
    s_cmp_eq_u32 s3, 0
    s_cbranch_scc0 L_noml
    s_lshl4_add_u32 s56, s5, s23
    v_and_or_b32 v200, v200, s16, v28
    v_and_or_b32 v201, v201, s16, v29
    v_and_or_b32 v202, v202, s16, v30
    v_and_or_b32 v203, v203, s16, v31
    s_mov_b64 exec, 1
    s_cmp_eq_u32 s98, 1
    s_cbranch_scc0 Lm_17
    buffer_store_dwordx4 v[200:203], v21, s[40:43], s56 offen
Lm_18:
    s_mov_b64 exec, -1
L_noml:
    s_add_u32 s56, s17, 64
    s_add_u32 s56, s56, 16
Lw_19:
    ds_read_b32 v32, v20 offset:0
    s_waitcnt lgkmcnt(0)
    v_readfirstlane_b32 s61, v32
    s_cmp_ge_i32 s61, s56
    s_cbranch_scc1 Ld_20
    s_sub_u32 s63, s63, 1
    s_cbranch_scc0 Lw_19
    s_endpgm
Ld_20:
    ds_read_b64_tr_b16 v[64:65], v16 offset:0
    ds_read_b64_tr_b16 v[66:67], v16 offset:1024
    ds_read_b64_tr_b16 v[68:69], v17 offset:0
    ds_read_b64_tr_b16 v[70:71], v17 offset:1024
    ds_read_b64_tr_b16 v[72:73], v16 offset:8192
    ds_read_b64_tr_b16 v[74:75], v16 offset:9216
    ds_read_b64_tr_b16 v[76:77], v17 offset:8192
    ds_read_b64_tr_b16 v[78:79], v17 offset:9216
    s_waitcnt lgkmcnt(6)
    v_mfma_f32_16x16x32_bf16 v[176:179], v[64:67], v[128:131], 0
    s_waitcnt lgkmcnt(4)
    v_mfma_f32_16x16x32_bf16 v[180:183], v[68:71], v[128:131], 0
    s_waitcnt lgkmcnt(2)
    v_mfma_f32_16x16x32_bf16 v[176:179], v[72:75], v[132:135], v[176:179]
    s_waitcnt lgkmcnt(0)
    v_mfma_f32_16x16x32_bf16 v[180:183], v[76:79], v[132:135], v[180:183]
    s_nop 5
    v_mul_f32 v184, v192, v176
    v_mul_f32 v185, v192, v177
    v_mul_f32 v186, v192, v178
    v_mul_f32 v187, v192, v179
    v_mul_f32 v188, v192, v180
    v_mul_f32 v189, v192, v181
    v_mul_f32 v190, v192, v182
    v_mul_f32 v191, v192, v183
    s_add_u32 s56, s56, 16
Lw_21:
    ds_read_b32 v32, v20 offset:0
    s_waitcnt lgkmcnt(0)
    v_readfirstlane_b32 s61, v32
    s_cmp_ge_i32 s61, s56
    s_cbranch_scc1 Ld_22
    s_sub_u32 s63, s63, 1
    s_cbranch_scc0 Lw_21
    s_endpgm
Ld_22:
    ds_read_b64_tr_b16 v[80:81], v16 offset:16384
    ds_read_b64_tr_b16 v[82:83], v16 offset:17408
    ds_read_b64_tr_b16 v[84:85], v17 offset:16384
    ds_read_b64_tr_b16 v[86:87], v17 offset:17408
    ds_read_b64_tr_b16 v[88:89], v16 offset:24576
    ds_read_b64_tr_b16 v[90:91], v16 offset:25600
    ds_read_b64_tr_b16 v[92:93], v17 offset:24576
    ds_read_b64_tr_b16 v[94:95], v17 offset:25600
    s_cmp_lt_u32 s5, 9
    s_cbranch_scc0 L_egB
    buffer_load_dwordx4 v[224:227], v51, s[40:43], s23 offen sc1
    s_branch L_egD
L_egB:
    buffer_load_dwordx4 v[220:223], v54, s[40:43], s32 offen sc1
    buffer_load_dwordx4 v[208:211], v52, s[40:43], s28 offen sc1
    buffer_load_dwordx4 v[212:215], v52, s[40:43], s22 offen sc1
    buffer_load_dwordx4 v[216:219], v52, s[40:43], s59 offen sc1
L_egD:
    s_waitcnt lgkmcnt(6)
    v_mfma_f32_16x16x32_bf16 v[176:179], v[80:83], v[136:139], 0
    s_waitcnt lgkmcnt(4)
    v_mfma_f32_16x16x32_bf16 v[180:183], v[84:87], v[136:139], 0
    s_waitcnt lgkmcnt(2)
    v_mfma_f32_16x16x32_bf16 v[176:179], v[88:91], v[140:143], v[176:179]
    s_waitcnt lgkmcnt(0)
    v_mfma_f32_16x16x32_bf16 v[180:183], v[92:95], v[140:143], v[180:183]
    s_nop 5
    v_fmac_f32 v184, v194, v176
    v_fmac_f32 v185, v194, v177
    v_fmac_f32 v186, v194, v178
    v_fmac_f32 v187, v194, v179
    v_fmac_f32 v188, v194, v180
    v_fmac_f32 v189, v194, v181
    v_fmac_f32 v190, v194, v182
    v_fmac_f32 v191, v194, v183
    s_add_u32 s56, s56, 16
Lw_23:
    ds_read_b32 v32, v20 offset:0
    s_waitcnt lgkmcnt(0)
    v_readfirstlane_b32 s61, v32
    s_cmp_ge_i32 s61, s56
    s_cbranch_scc1 Ld_24
    s_sub_u32 s63, s63, 1
    s_cbranch_scc0 Lw_23
    s_endpgm
Ld_24:
    ds_read_b64_tr_b16 v[96:97], v16 offset:32768
    ds_read_b64_tr_b16 v[98:99], v16 offset:33792
    ds_read_b64_tr_b16 v[100:101], v17 offset:32768
    ds_read_b64_tr_b16 v[102:103], v17 offset:33792
    ds_read_b64_tr_b16 v[104:105], v16 offset:40960
    ds_read_b64_tr_b16 v[106:107], v16 offset:41984
    ds_read_b64_tr_b16 v[108:109], v17 offset:40960
    ds_read_b64_tr_b16 v[110:111], v17 offset:41984
    s_waitcnt lgkmcnt(6)
    v_mfma_f32_16x16x32_bf16 v[176:179], v[96:99], v[144:147], 0
    s_waitcnt lgkmcnt(4)
    v_mfma_f32_16x16x32_bf16 v[180:183], v[100:103], v[144:147], 0
    s_waitcnt lgkmcnt(2)
    v_mfma_f32_16x16x32_bf16 v[176:179], v[104:107], v[148:151], v[176:179]
    s_waitcnt lgkmcnt(0)
    v_mfma_f32_16x16x32_bf16 v[180:183], v[108:111], v[148:151], v[180:183]
    s_nop 5
    v_fmac_f32 v184, v196, v176
    v_fmac_f32 v185, v196, v177
    v_fmac_f32 v186, v196, v178
    v_fmac_f32 v187, v196, v179
    v_fmac_f32 v188, v196, v180
    v_fmac_f32 v189, v196, v181
    v_fmac_f32 v190, v196, v182
    v_fmac_f32 v191, v196, v183
    s_add_u32 s56, s56, 8
Lw_25:
    ds_read_b32 v32, v20 offset:0
    s_waitcnt lgkmcnt(0)
    v_readfirstlane_b32 s61, v32
    s_cmp_ge_i32 s61, s56
    s_cbranch_scc1 Ld_26
    s_sub_u32 s63, s63, 1
    s_cbranch_scc0 Lw_25
    s_endpgm
Ld_26:
    ds_read_b64_tr_b16 v[112:113], v16 offset:49152
    ds_read_b64_tr_b16 v[114:115], v16 offset:50176
    ds_read_b64_tr_b16 v[116:117], v17 offset:49152
    ds_read_b64_tr_b16 v[118:119], v17 offset:50176
    s_waitcnt lgkmcnt(2)
    v_mfma_f32_16x16x32_bf16 v[176:179], v[112:115], v[152:155], 0
    s_waitcnt lgkmcnt(0)
    v_mfma_f32_16x16x32_bf16 v[180:183], v[116:119], v[152:155], 0
    s_add_u32 s56, s56, 8
Lw_27:
    ds_read_b32 v32, v20 offset:0
    s_waitcnt lgkmcnt(0)
    v_readfirstlane_b32 s61, v32
    s_cmp_ge_i32 s61, s56
    s_cbranch_scc1 Ld_28
    s_sub_u32 s63, s63, 1
    s_cbranch_scc0 Lw_27
    s_endpgm
Ld_28:
    ds_read_b64_tr_b16 v[120:121], v16 offset:57344
    ds_read_b64_tr_b16 v[122:123], v16 offset:58368
    ds_read_b64_tr_b16 v[124:125], v17 offset:57344
    ds_read_b64_tr_b16 v[126:127], v17 offset:58368
    s_waitcnt lgkmcnt(2)
    v_mfma_f32_16x16x32_bf16 v[176:179], v[120:123], v[156:159], v[176:179]
    s_waitcnt lgkmcnt(0)
    v_mfma_f32_16x16x32_bf16 v[180:183], v[124:127], v[156:159], v[180:183]
    s_nop 5
    v_fmac_f32 v184, v198, v176
    v_fmac_f32 v185, v198, v177
    v_fmac_f32 v186, v198, v178
    v_fmac_f32 v187, v198, v179
    v_fmac_f32 v188, v198, v180
    v_fmac_f32 v189, v198, v181
    v_fmac_f32 v190, v198, v182
    v_fmac_f32 v191, v198, v183
    v_cvt_pk_bf16_f32 v204, v184, v185
    v_cvt_pk_bf16_f32 v205, v186, v187
    v_cvt_pk_bf16_f32 v206, v188, v189
    v_cvt_pk_bf16_f32 v207, v190, v191
    v_min_u32 v204, -2, v204
    v_min_u32 v205, -2, v205
    v_min_u32 v206, -2, v206
    v_min_u32 v207, -2, v207
    s_mov_b64 exec, s[26:27]
    s_cmp_eq_u32 s98, 1
    s_cbranch_scc0 Lm_29
    buffer_store_dwordx4 v[204:207], v24, s[40:43], s25 offen
Lm_30:
    s_mov_b64 exec, 1
    ds_add_u32 v20, v40 offset:292
    s_mov_b64 exec, -1
    s_cmp_lt_u32 s5, 9
    s_cbranch_scc0 L_gB
    s_waitcnt vmcnt(1)
L_mlchk:
    v_xor_b32 v224, s12, v224
    v_xor_b32 v225, s13, v225
    v_xor_b32 v226, s14, v226
    v_xor_b32 v227, s15, v227
    v_or3_b32 v32, v224, v225, v226
    v_or_b32 v32, v32, v227
    v_and_b32 v32, 0xff, v32
    v_cmp_ne_u32 vcc, 0, v32
    s_cbranch_vccnz L_mlre
    buffer_load_dwordx4 v[208:211], v21, s[40:43], s29 offen sc1
    buffer_load_dwordx4 v[212:215], v21, s[40:43], s29 offen offset:1024 sc1
    s_cmp_lt_u32 s3, 2
    s_cselect_b64 vcc, 0, -1
    v_cndmask_b32 v224, v224, v226, vcc
    v_cndmask_b32 v225, v225, v227, vcc
    s_nop 0
    v_max_f32_dpp v226, v224, v224 quad_perm:[1,0,3,2] row_mask:0xf bank_mask:0xf
    s_nop 1
    v_max_f32_dpp v226, v226, v226 quad_perm:[2,3,0,1] row_mask:0xf bank_mask:0xf
    v_sub_f32 v224, v224, v226
    v_exp_f32 v224, v224
    s_nop 0
    v_mul_f32 v225, v224, v225
    s_nop 1
    v_add_f32_dpp v226, v225, v225 quad_perm:[1,0,3,2] row_mask:0xf bank_mask:0xf
    s_nop 1
    v_add_f32_dpp v226, v226, v226 quad_perm:[2,3,0,1] row_mask:0xf bank_mask:0xf
    v_rcp_f32 v226, v226
    s_nop 0
    v_mul_f32 v228, v224, v226
    s_lshl2_add_u32 s56, s3, s17
    s_addk_i32 s56, 132
Lw_31:
    ds_read_b32 v32, v20 offset:0
    s_waitcnt lgkmcnt(0)
    v_readfirstlane_b32 s61, v32
    s_cmp_ge_i32 s61, s56
    s_cbranch_scc1 Ld_32
    s_sub_u32 s63, s63, 1
    s_cbranch_scc0 Lw_31
    s_endpgm
Ld_32:
    buffer_load_dwordx4 v[208:211], v21, s[40:43], s29 offen sc1
    buffer_load_dwordx4 v[212:215], v21, s[40:43], s29 offen offset:1024 sc1
    ds_read_b64_tr_b16 v[64:65], v4 offset:0
    ds_read_b64_tr_b16 v[66:67], v4 offset:2048
    ds_read_b64_tr_b16 v[68:69], v5 offset:0
    ds_read_b64_tr_b16 v[70:71], v5 offset:2048
    ds_read_b64_tr_b16 v[72:73], v6 offset:0
    ds_read_b64_tr_b16 v[74:75], v6 offset:2048
    ds_read_b64_tr_b16 v[76:77], v7 offset:0
    ds_read_b64_tr_b16 v[78:79], v7 offset:2048
    s_addk_i32 s56, 16
L_ol1:
    ds_read_b32 v34, v20
    s_waitcnt vmcnt(2)
    v_max3_u32 v32, v208, v209, v210
    v_max3_u32 v33, v211, v212, v213
    v_max3_u32 v32, v32, v214, v215
    v_max_u32 v32, v32, v33
    v_cmp_eq_u32 vcc, -1, v32
    s_cbranch_vccz L_ogoA
    buffer_load_dwordx4 v[208:211], v21, s[40:43], s29 offen sc1
    buffer_load_dwordx4 v[212:215], v21, s[40:43], s29 offen offset:1024 sc1
    s_waitcnt lgkmcnt(0)
    v_readfirstlane_b32 s61, v34
    s_cmp_ge_i32 s61, s56
    s_cbranch_scc1 L_ol2
    s_sub_u32 s63, s63, 1
    s_cbranch_scc0 L_ol1
    s_endpgm
L_ogoA:
    s_waitcnt lgkmcnt(0)
    v_mfma_f32_16x16x32_bf16 v[176:179], v[208:211], v[64:67], 0
    v_mfma_f32_16x16x32_bf16 v[180:183], v[208:211], v[68:71], 0
    v_mfma_f32_16x16x32_bf16 v[184:187], v[208:211], v[72:75], 0
    v_mfma_f32_16x16x32_bf16 v[188:191], v[208:211], v[76:79], 0
Lw_33:
    ds_read_b32 v32, v20 offset:0
    s_waitcnt lgkmcnt(0)
    v_readfirstlane_b32 s61, v32
    s_cmp_ge_i32 s61, s56
    s_cbranch_scc1 Ld_34
    s_sub_u32 s63, s63, 1
    s_cbranch_scc0 Lw_33
    s_endpgm
Ld_34:
    ds_read_b64_tr_b16 v[80:81], v4 offset:16384
    ds_read_b64_tr_b16 v[82:83], v4 offset:18432
    ds_read_b64_tr_b16 v[84:85], v5 offset:16384
    ds_read_b64_tr_b16 v[86:87], v5 offset:18432
    ds_read_b64_tr_b16 v[88:89], v6 offset:16384
    ds_read_b64_tr_b16 v[90:91], v6 offset:18432
    ds_read_b64_tr_b16 v[92:93], v7 offset:16384
    ds_read_b64_tr_b16 v[94:95], v7 offset:18432
    s_branch L_ogo1
L_ol2:
    ds_read_b64_tr_b16 v[80:81], v4 offset:16384
    ds_read_b64_tr_b16 v[82:83], v4 offset:18432
    ds_read_b64_tr_b16 v[84:85], v5 offset:16384
    ds_read_b64_tr_b16 v[86:87], v5 offset:18432
    ds_read_b64_tr_b16 v[88:89], v6 offset:16384
    ds_read_b64_tr_b16 v[90:91], v6 offset:18432
    ds_read_b64_tr_b16 v[92:93], v7 offset:16384
    ds_read_b64_tr_b16 v[94:95], v7 offset:18432
L_oloop:
    s_waitcnt vmcnt(2)
    v_max3_u32 v32, v208, v209, v210
    v_max3_u32 v33, v211, v212, v213
    v_max3_u32 v32, v32, v214, v215
    v_max_u32 v32, v32, v33
    v_cmp_eq_u32 vcc, -1, v32
    s_cbranch_vccz L_ogo
    buffer_load_dwordx4 v[208:211], v21, s[40:43], s29 offen sc1
    buffer_load_dwordx4 v[212:215], v21, s[40:43], s29 offen offset:1024 sc1
    s_sub_u32 s63, s63, 1
    s_cbranch_scc0 L_oloop
    s_endpgm
L_ogo:
    s_waitcnt lgkmcnt(8)
    v_mfma_f32_16x16x32_bf16 v[176:179], v[208:211], v[64:67], 0
    v_mfma_f32_16x16x32_bf16 v[180:183], v[208:211], v[68:71], 0
    v_mfma_f32_16x16x32_bf16 v[184:187], v[208:211], v[72:75], 0
    v_mfma_f32_16x16x32_bf16 v[188:191], v[208:211], v[76:79], 0
L_ogo1:
    s_waitcnt lgkmcnt(6)
    v_mfma_f32_16x16x32_bf16 v[176:179], v[212:215], v[80:83], v[176:179]
    s_waitcnt lgkmcnt(4)
    v_mfma_f32_16x16x32_bf16 v[180:183], v[212:215], v[84:87], v[180:183]
    s_waitcnt lgkmcnt(2)
    v_mfma_f32_16x16x32_bf16 v[184:187], v[212:215], v[88:91], v[184:187]
    s_waitcnt lgkmcnt(0)
    v_mfma_f32_16x16x32_bf16 v[188:191], v[212:215], v[92:95], v[188:191]
    s_nop 1
    v_mul_f32_dpp v192, v228, v176 quad_perm:[0,0,0,0] row_mask:0xf bank_mask:0xf
    s_nop 0
    v_mul_f32_dpp v193, v228, v180 quad_perm:[0,0,0,0] row_mask:0xf bank_mask:0xf
    s_nop 0
    v_mul_f32_dpp v194, v228, v184 quad_perm:[0,0,0,0] row_mask:0xf bank_mask:0xf
    s_nop 0
    v_mul_f32_dpp v195, v228, v188 quad_perm:[0,0,0,0] row_mask:0xf bank_mask:0xf
    v_fmac_f32_dpp v192, v228, v177 quad_perm:[1,1,1,1] row_mask:0xf bank_mask:0xf
    v_fmac_f32_dpp v193, v228, v181 quad_perm:[1,1,1,1] row_mask:0xf bank_mask:0xf
    v_fmac_f32_dpp v194, v228, v185 quad_perm:[1,1,1,1] row_mask:0xf bank_mask:0xf
    v_fmac_f32_dpp v195, v228, v189 quad_perm:[1,1,1,1] row_mask:0xf bank_mask:0xf
    v_fmac_f32_dpp v192, v228, v178 quad_perm:[2,2,2,2] row_mask:0xf bank_mask:0xf
    v_fmac_f32_dpp v193, v228, v182 quad_perm:[2,2,2,2] row_mask:0xf bank_mask:0xf
    v_fmac_f32_dpp v194, v228, v186 quad_perm:[2,2,2,2] row_mask:0xf bank_mask:0xf
    v_fmac_f32_dpp v195, v228, v190 quad_perm:[2,2,2,2] row_mask:0xf bank_mask:0xf
    v_fmac_f32_dpp v192, v228, v179 quad_perm:[3,3,3,3] row_mask:0xf bank_mask:0xf
    v_fmac_f32_dpp v193, v228, v183 quad_perm:[3,3,3,3] row_mask:0xf bank_mask:0xf
    v_fmac_f32_dpp v194, v228, v187 quad_perm:[3,3,3,3] row_mask:0xf bank_mask:0xf
    v_fmac_f32_dpp v195, v228, v191 quad_perm:[3,3,3,3] row_mask:0xf bank_mask:0xf
L_red:
    ds_write2_b32 v53, v192, v193 offset0:0 offset1:16
    ds_write2_b32 v53, v194, v195 offset0:32 offset1:48
    ds_add_rtn_u32 v32, v50, v40 offset:27776
    s_waitcnt lgkmcnt(0)
    v_cmp_eq_u32 vcc, 3, v32
    s_and_b64 exec, exec, vcc
    s_cbranch_execz L_fin
    ds_read_b128 v[128:131], v21 offset:28672
    ds_read_b128 v[132:135], v21 offset:29696
    ds_read_b128 v[136:139], v21 offset:30720
    ds_read_b128 v[140:143], v21 offset:31744
    s_waitcnt lgkmcnt(2)
    v_pk_add_f32 v[128:129], v[128:129], v[132:133]
    v_pk_add_f32 v[130:131], v[130:131], v[134:135]
    s_waitcnt lgkmcnt(1)
    v_pk_add_f32 v[128:129], v[128:129], v[136:137]
    v_pk_add_f32 v[130:131], v[130:131], v[138:139]
    s_waitcnt lgkmcnt(0)
    v_pk_add_f32 v[128:129], v[128:129], v[140:141]
    v_pk_add_f32 v[130:131], v[130:131], v[142:143]
    v_and_or_b32 v128, v128, s16, v28
    v_and_or_b32 v129, v129, s16, v29
    v_and_or_b32 v130, v130, s16, v30
    v_and_or_b32 v131, v131, s16, v31
    buffer_store_dwordx4 v[128:131], v21, s[40:43], s31 offen sc1
L_fst:
L_fin:
    s_mov_b64 exec, -1
    s_cmp_lt_u32 s96, 36
    s_cbranch_scc0 L_done
L_fpoll:
    s_or_b64 exec, s[28:29], 1
    buffer_load_dwordx4 v[220:223], v34, s[40:43], s57 offen sc1
    s_or_b64 exec, s[26:27], 1
    buffer_load_dwordx4 v[216:219], v34, s[40:43], s56 offen sc1
    s_mov_b64 exec, s[28:29]
    s_waitcnt vmcnt(3)
    v_xor_b32 v148, s12, v212
    v_xor_b32 v149, s13, v213
    v_xor_b32 v150, s14, v214
    v_xor_b32 v151, s15, v215
    v_or3_b32 v32, v148, v149, v150
    v_or_b32 v32, v32, v151
    v_cmp_ne_u32_sdwa s[28:29], v32, v38 src0_sel:BYTE_0 src1_sel:DWORD
    v_mul_f32 v148, v33, v148
    v_mul_f32 v149, v33, v149
    v_mul_f32 v150, v33, v150
    v_mul_f32 v151, v33, v151
    s_mov_b64 exec, s[26:27]
    s_waitcnt vmcnt(2)
    v_xor_b32 v144, s12, v208
    v_xor_b32 v145, s13, v209
    v_xor_b32 v146, s14, v210
    v_xor_b32 v147, s15, v211
    v_or3_b32 v32, v144, v145, v146
    v_or_b32 v32, v32, v147
    v_cmp_ne_u32_sdwa s[26:27], v32, v38 src0_sel:BYTE_0 src1_sel:DWORD
    s_or_b64 s[30:31], s[26:27], s[28:29]
    s_cbranch_scc0 L_fok
    s_or_b64 exec, s[28:29], 1
    buffer_load_dwordx4 v[212:215], v34, s[40:43], s57 offen sc1
    s_or_b64 exec, s[26:27], 1
    buffer_load_dwordx4 v[208:211], v34, s[40:43], s56 offen sc1
    s_mov_b64 exec, s[28:29]
    s_waitcnt vmcnt(3)
    v_xor_b32 v148, s12, v220
    v_xor_b32 v149, s13, v221
    v_xor_b32 v150, s14, v222
    v_xor_b32 v151, s15, v223
    v_or3_b32 v32, v148, v149, v150
    v_or_b32 v32, v32, v151
    v_cmp_ne_u32_sdwa s[28:29], v32, v38 src0_sel:BYTE_0 src1_sel:DWORD
    v_mul_f32 v148, v33, v148
    v_mul_f32 v149, v33, v149
    v_mul_f32 v150, v33, v150
    v_mul_f32 v151, v33, v151
    s_mov_b64 exec, s[26:27]
    s_waitcnt vmcnt(2)
    v_xor_b32 v144, s12, v216
    v_xor_b32 v145, s13, v217
    v_xor_b32 v146, s14, v218
    v_xor_b32 v147, s15, v219
    v_or3_b32 v32, v144, v145, v146
    v_or_b32 v32, v32, v147
    v_cmp_ne_u32_sdwa s[26:27], v32, v38 src0_sel:BYTE_0 src1_sel:DWORD
    s_or_b64 s[30:31], s[26:27], s[28:29]
    s_cbranch_scc0 L_fok
    s_sub_u32 s63, s63, 1
    s_cbranch_scc0 L_fpoll
    s_endpgm
L_fok:
    s_mov_b64 exec, -1
    v_fmac_f32 v148, v44, v144
    v_fmac_f32 v150, v44, v146
    v_fmac_f32 v149, v44, v145
    v_fmac_f32 v151, v44, v147
    v_permlane32_swap_b32 v148, v150
    s_nop 0
    v_permlane32_swap_b32 v149, v151
    v_add_f32 v148, v148, v150
    v_add_f32 v149, v149, v151
    s_nop 1
    v_permlane16_swap_b32 v148, v149
    v_add_f32 v148, v148, v149
    s_nop 1
    v_add_f32_dpp v148, v148, v148 row_ror:4 row_mask:0xf bank_mask:0xf
    s_nop 1
    v_add_f32_dpp v148, v148, v148 row_ror:8 row_mask:0xf bank_mask:0xf
    s_mov_b64 exec, s[18:19]
    v_cvt_pk_bf16_f32 v148, v148, v148
    buffer_store_short v148, v35, s[48:51], s58 offen
    s_or_b32 s56, s96, s3
    s_cbranch_scc1 L_done
    s_mov_b64 exec, -1
    v_mov_b32 v34, s11
    buffer_store_dword v34, v50, s[40:43], 0 offen
L_done:
L_end:
    s_endpgm
L_gB:
    s_waitcnt vmcnt(1)
    v_xor_b32 v220, v45, v220
    v_xor_b32 v221, s13, v221
    v_xor_b32 v222, s14, v222
    v_xor_b32 v223, s15, v223
    v_or3_b32 v32, v221, v222, v223
    v_and_b32 v32, 0xff, v32
    v_and_b32 v220, 0x7ff, v220
    v_or_b32 v32, v32, v220
    v_cmp_ne_u32 vcc, 0, v32
    s_cmp_eq_u64 vcc, 0
    s_cselect_b32 s33, 1, 0
    s_cmp_eq_u32 s8, 8
    s_cselect_b32 s33, 0, s33
L_hchk:
    v_xor_b32 v208, s12, v208
    v_xor_b32 v209, s13, v209
    v_xor_b32 v210, s14, v210
    v_xor_b32 v211, s15, v211
    v_or3_b32 v32, v208, v209, v210
    v_or_b32 v32, v32, v211
    v_xor_b32 v212, s12, v212
    v_xor_b32 v213, s13, v213
    v_xor_b32 v214, s14, v214
    v_xor_b32 v215, s15, v215
    v_or3_b32 v32, v32, v212, v213
    v_or3_b32 v32, v32, v214, v215
    v_xor_b32 v216, s12, v216
    v_xor_b32 v217, s13, v217
    v_xor_b32 v218, s14, v218
    v_xor_b32 v219, s15, v219
    v_or3_b32 v32, v32, v216, v217
    v_or3_b32 v32, v32, v218, v219
    v_and_b32 v32, 0xff, v32
    v_cmp_ne_u32 vcc, 0, v32
    s_cbranch_vccz L_hok
    buffer_load_dwordx4 v[208:211], v52, s[40:43], s28 offen sc1
    buffer_load_dwordx4 v[212:215], v52, s[40:43], s22 offen sc1
    buffer_load_dwordx4 v[216:219], v52, s[40:43], s59 offen sc1
    s_sub_u32 s63, s63, 1
    s_cbranch_scc1 L_end
    s_waitcnt vmcnt(0)
    s_branch L_hchk
L_hok:
    v_add_f32_dpp v208, v208, v208 quad_perm:[1,0,3,2] row_mask:0xf bank_mask:0xf
    v_add_f32_dpp v209, v209, v209 quad_perm:[1,0,3,2] row_mask:0xf bank_mask:0xf
    v_add_f32_dpp v210, v210, v210 quad_perm:[1,0,3,2] row_mask:0xf bank_mask:0xf
    v_add_f32_dpp v211, v211, v211 quad_perm:[1,0,3,2] row_mask:0xf bank_mask:0xf
    v_add_f32_dpp v212, v212, v212 quad_perm:[1,0,3,2] row_mask:0xf bank_mask:0xf
    v_add_f32_dpp v213, v213, v213 quad_perm:[1,0,3,2] row_mask:0xf bank_mask:0xf
    v_add_f32_dpp v214, v214, v214 quad_perm:[1,0,3,2] row_mask:0xf bank_mask:0xf
    v_add_f32_dpp v215, v215, v215 quad_perm:[1,0,3,2] row_mask:0xf bank_mask:0xf
    v_add_f32_dpp v216, v216, v216 quad_perm:[1,0,3,2] row_mask:0xf bank_mask:0xf
    v_add_f32_dpp v217, v217, v217 quad_perm:[1,0,3,2] row_mask:0xf bank_mask:0xf
    v_add_f32_dpp v218, v218, v218 quad_perm:[1,0,3,2] row_mask:0xf bank_mask:0xf
    v_add_f32_dpp v219, v219, v219 quad_perm:[1,0,3,2] row_mask:0xf bank_mask:0xf
    v_max_f32 v208, 0, v208
    v_max_f32 v209, 0, v209
    v_max_f32 v210, 0, v210
    v_max_f32 v211, 0, v211
    v_max_f32 v212, 0, v212
    v_max_f32 v213, 0, v213
    v_max_f32 v214, 0, v214
    v_max_f32 v215, 0, v215
    v_max_f32 v216, 0, v216
    v_max_f32 v217, 0, v217
    v_max_f32 v218, 0, v218
    v_max_f32 v219, 0, v219
    v_cvt_pk_bf16_f32 v208, v208, v209
    v_cvt_pk_bf16_f32 v209, v210, v211
    v_cvt_pk_bf16_f32 v210, v212, v213
    v_cvt_pk_bf16_f32 v211, v214, v215
    v_cvt_pk_bf16_f32 v212, v216, v217
    v_cvt_pk_bf16_f32 v213, v218, v219
    v_mov_b32_dpp v224, v208 quad_perm:[0,0,0,0] row_mask:0xf bank_mask:0xf
    v_mov_b32_dpp v225, v209 quad_perm:[0,0,0,0] row_mask:0xf bank_mask:0xf
    v_mov_b32_dpp v226, v208 quad_perm:[2,2,2,2] row_mask:0xf bank_mask:0xf
    v_mov_b32_dpp v227, v209 quad_perm:[2,2,2,2] row_mask:0xf bank_mask:0xf
    v_mov_b32_dpp v228, v210 quad_perm:[0,0,0,0] row_mask:0xf bank_mask:0xf
    v_mov_b32_dpp v229, v211 quad_perm:[0,0,0,0] row_mask:0xf bank_mask:0xf
    v_mov_b32_dpp v230, v210 quad_perm:[2,2,2,2] row_mask:0xf bank_mask:0xf
    v_mov_b32_dpp v231, v211 quad_perm:[2,2,2,2] row_mask:0xf bank_mask:0xf
    v_mov_b32_dpp v232, v212 quad_perm:[0,0,0,0] row_mask:0xf bank_mask:0xf
    v_mov_b32_dpp v233, v213 quad_perm:[0,0,0,0] row_mask:0xf bank_mask:0xf
    v_mov_b32_dpp v234, v212 quad_perm:[2,2,2,2] row_mask:0xf bank_mask:0xf
    v_mov_b32_dpp v235, v213 quad_perm:[2,2,2,2] row_mask:0xf bank_mask:0xf
    s_lshl_b32 s56, s3, 10
    v_add_u32 v60, s56, v21
    ds_write_b128 v60, v[224:227] offset:0
    ds_write_b128 v60, v[228:231] offset:4096
    ds_write_b128 v60, v[232:235] offset:8192
    s_mov_b64 exec, 1
    ds_add_u32 v20, v40 offset:288
    s_mov_b64 exec, -1
    s_cmp_eq_u32 s8, 8
    s_cselect_b32 s56, 8, 11
    s_lshl_b32 s57, s56, 10
    s_lshl_b32 s56, s56, 12
    v_add_u32 v58, 32768, v8
    v_add_u32 v59, s56, v58
    v_add_u32 v60, s57, v21
    v_lshrrev_b32 v61, 2, v3
    v_lshlrev_b32 v61, 8, v61
    v_lshl_add_u32 v61, v2, 4, v61
    s_lshl_b32 s56, s3, 6
    s_add_u32 s31, s31, s56
    s_sub_u32 s52, s30, 4
    s_mov_b32 s22, 0x11111111
    s_mov_b32 s23, s22
    s_cmp_lt_u32 s96, 36
    s_cbranch_scc0 L_nrs
    s_and_b32 s56, s2, 7
    s_sub_u32 s57, s96, 4
    s_cselect_b32 s56, 8, s56
    s_cselect_b32 s29, -1, 0xffff
    s_lshr_b32 s57, s57, 3
    s_min_u32 s57, s57, s96
    s_lshl_b32 s58, s56, 7
    s_lshl_b32 s59, s3, 5
    s_add_u32 s58, s58, s59
    s_mul_i32 s59, s57, 1152
    s_add_u32 s58, s58, s59
    s_lshl_b32 s59, s57, 2
    s_lshl_b32 s56, s56, 15
    s_lshl2_add_u32 s57, s57, s3
    s_lshl_b32 s57, s57, 6
    s_add_u32 s56, s56, s57
    s_add_u32 s56, s56, 1572864
    s_add_u32 s57, s56, 16384
    v_lshrrev_b32 v34, 2, v1
    v_and_b32 v35, 3, v1
    v_lshlrev_b32 v34, 10, v34
    v_lshl_add_u32 v34, v35, 4, v34
    v_mov_b32 v36, s59
    ds_read_b32 v44, v36 offset:27536
    v_lshlrev_b32 v35, 3, v35
    v_lshl_add_u32 v35, v2, 1, v35
    v_mov_b32 v148, 0
    v_mov_b32 v149, 0
    v_mov_b32 v150, 0
    v_mov_b32 v151, 0
    s_mov_b64 s[26:27], -1
    s_mov_b32 s28, -1
    s_waitcnt lgkmcnt(0)
    v_sub_f32 v33, 1.0, v44
    v_mov_b32 v38, 0
L_nrs:
Lw_35:
    ds_read_b32 v32, v20 offset:288
    s_waitcnt lgkmcnt(0)
    v_readfirstlane_b32 s61, v32
    s_cmp_ge_i32 s61, 4
    s_cbranch_scc1 Ld_36
    s_sub_u32 s63, s63, 1
    s_cbranch_scc0 Lw_35
    s_endpgm
Ld_36:
    ds_read_b128 v[112:115], v21 offset:0
    ds_read_b128 v[116:119], v21 offset:1024
    ds_read_b128 v[120:123], v21 offset:2048
    ds_read_b128 v[124:127], v21 offset:3072
    ds_read_b128 v[128:131], v21 offset:4096
    ds_read_b128 v[132:135], v21 offset:5120
    ds_read_b128 v[136:139], v21 offset:6144
    ds_read_b128 v[140:143], v21 offset:7168
    ds_read_b128 v[152:155], v21 offset:8192
    ds_read_b128 v[156:159], v21 offset:9216
    ds_read_b128 v[160:163], v21 offset:10240
    ds_read_b128 v[164:167], v60 offset:0
Lw_37:
    ds_read_b32 v32, v20 offset:0
    s_waitcnt lgkmcnt(0)
    v_readfirstlane_b32 s61, v32
    s_cmp_ge_i32 s61, s54
    s_cbranch_scc1 Ld_38
    s_sub_u32 s63, s63, 1
    s_cbranch_scc0 Lw_37
    s_endpgm
Ld_38:
    ds_read_b64_tr_b16 v[64:65], v58 offset:0
    ds_read_b64_tr_b16 v[66:67], v58 offset:2048
    ds_read_b64_tr_b16 v[68:69], v58 offset:4096
    ds_read_b64_tr_b16 v[70:71], v58 offset:6144
    ds_read_b64_tr_b16 v[72:73], v58 offset:8192
    ds_read_b64_tr_b16 v[74:75], v58 offset:10240
    ds_read_b64_tr_b16 v[76:77], v58 offset:12288
    ds_read_b64_tr_b16 v[78:79], v58 offset:14336
    s_waitcnt lgkmcnt(6)
    v_mfma_f32_16x16x32_bf16 v[176:179], v[64:67], v[112:115], 0
    s_waitcnt lgkmcnt(4)
    v_mfma_f32_16x16x32_bf16 v[176:179], v[68:71], v[116:119], v[176:179]
    s_waitcnt lgkmcnt(2)
    v_mfma_f32_16x16x32_bf16 v[176:179], v[72:75], v[120:123], v[176:179]
    s_waitcnt lgkmcnt(0)
    v_mfma_f32_16x16x32_bf16 v[176:179], v[76:79], v[124:127], v[176:179]
Lw_39:
    ds_read_b32 v32, v20 offset:0
    s_waitcnt lgkmcnt(0)
    v_readfirstlane_b32 s61, v32
    s_cmp_ge_i32 s61, s55
    s_cbranch_scc1 Ld_40
    s_sub_u32 s63, s63, 1
    s_cbranch_scc0 Lw_39
    s_endpgm
Ld_40:
    ds_read_b64_tr_b16 v[80:81], v58 offset:16384
    ds_read_b64_tr_b16 v[82:83], v58 offset:18432
    ds_read_b64_tr_b16 v[84:85], v58 offset:20480
    ds_read_b64_tr_b16 v[86:87], v58 offset:22528
    ds_read_b64_tr_b16 v[88:89], v58 offset:24576
    ds_read_b64_tr_b16 v[90:91], v58 offset:26624
    ds_read_b64_tr_b16 v[92:93], v58 offset:28672
    ds_read_b64_tr_b16 v[94:95], v58 offset:30720
    s_waitcnt lgkmcnt(6)
    v_mfma_f32_16x16x32_bf16 v[176:179], v[80:83], v[128:131], v[176:179]
    s_waitcnt lgkmcnt(4)
    v_mfma_f32_16x16x32_bf16 v[176:179], v[84:87], v[132:135], v[176:179]
    s_waitcnt lgkmcnt(2)
    v_mfma_f32_16x16x32_bf16 v[176:179], v[88:91], v[136:139], v[176:179]
    s_waitcnt lgkmcnt(0)
    v_mfma_f32_16x16x32_bf16 v[176:179], v[92:95], v[140:143], v[176:179]
    s_cmp_lt_u32 s96, 36
    s_cbranch_scc0 L_nre
    s_or_b64 exec, s[28:29], 1
    buffer_load_dwordx4 v[212:215], v34, s[40:43], s57 offen sc1
    s_or_b64 exec, s[26:27], 1
    buffer_load_dwordx4 v[208:211], v34, s[40:43], s56 offen sc1
    s_mov_b64 exec, -1
L_nre:
    s_cmp_eq_u32 s8, 8
    s_cbranch_scc1 L_b2
Lw_41:
    ds_read_b32 v32, v20 offset:0
    s_waitcnt lgkmcnt(0)
    v_readfirstlane_b32 s61, v32
    s_cmp_ge_i32 s61, s52
    s_cbranch_scc1 Ld_42
    s_sub_u32 s63, s63, 1
    s_cbranch_scc0 Lw_41
    s_endpgm
Ld_42:
    ds_read_b64_tr_b16 v[96:97], v58 offset:32768
    ds_read_b64_tr_b16 v[98:99], v58 offset:34816
    ds_read_b64_tr_b16 v[100:101], v58 offset:36864
    ds_read_b64_tr_b16 v[102:103], v58 offset:38912
    ds_read_b64_tr_b16 v[104:105], v58 offset:40960
    ds_read_b64_tr_b16 v[106:107], v58 offset:43008
    s_waitcnt lgkmcnt(4)
    v_mfma_f32_16x16x32_bf16 v[176:179], v[96:99], v[152:155], v[176:179]
    s_waitcnt lgkmcnt(2)
    v_mfma_f32_16x16x32_bf16 v[176:179], v[100:103], v[156:159], v[176:179]
    s_waitcnt lgkmcnt(0)
    v_mfma_f32_16x16x32_bf16 v[176:179], v[104:107], v[160:163], v[176:179]
L_b2:
Lw_43:
    ds_read_b32 v32, v20 offset:0
    s_waitcnt lgkmcnt(0)
    v_readfirstlane_b32 s61, v32
    s_cmp_ge_i32 s61, s30
    s_cbranch_scc1 Ld_44
    s_sub_u32 s63, s63, 1
    s_cbranch_scc0 Lw_43
    s_endpgm
Ld_44:
    ds_read_b64_tr_b16 v[108:109], v59 offset:0
    ds_read_b64_tr_b16 v[110:111], v59 offset:2048
    s_waitcnt lgkmcnt(0)
    v_mfma_f32_16x16x32_bf16 v[176:179], v[108:111], v[164:167], v[176:179]
    s_cmp_eq_u32 s33, 1
    s_mov_b64 exec, s[22:23]
    s_nop 5
    v_and_or_b32 v176, v176, s16, v28
    v_and_or_b32 v177, v177, s16, v29
    v_and_or_b32 v178, v178, s16, v30
    v_and_or_b32 v179, v179, s16, v31
    s_cbranch_scc0 L_bfar
    buffer_store_dwordx4 v[176:179], v61, s[40:43], s31 offen
    s_branch L_fst
L_bfar:
    buffer_store_dwordx4 v[176:179], v61, s[40:43], s31 offen sc1
    s_branch L_fst
L_qto:
    s_movk_i32 s58, 1
    s_xor_b32 s56, s56, 2097152
    s_cmpk_eq_u32 s57, 0xff
    s_cbranch_scc1 L_qcont
    v_lshlrev_b32 v33, 4, v3
    v_lshl_add_u32 v33, v2, 12, v33
    s_xor_b32 s59, s99, 2097152
L_qcp:
    buffer_load_dwordx4 v[208:211], v33, s[40:43], s59 offen sc1
    s_sub_u32 s63, s63, 1
    s_cbranch_scc1 L_end
    s_waitcnt vmcnt(0)
    v_xor_b32 v212, s12, v208
    v_xor_b32 v213, s13, v209
    v_xor_b32 v214, s14, v210
    v_xor_b32 v215, s15, v211
    v_or3_b32 v32, v212, v213, v214
    v_or_b32 v32, v32, v215
    v_and_b32 v32, 0xff, v32
    v_cmp_ne_u32 vcc, 0, v32
    s_cbranch_vccnz L_qcp
    buffer_store_dwordx4 v[208:211], v33, s[40:43], s99 offen sc1
    s_movk_i32 s57, 0xff
    s_waitcnt vmcnt(0)
    s_branch L_qcont
L_rsent:
    s_mov_b32 s21, 131072
    s_add_u32 s25, s25, s21
    s_mov_b64 exec, s[26:27]
    buffer_store_dwordx4 v[204:207], v24, s[40:43], s25 offen sc1
    s_mov_b64 exec, -1
    s_waitcnt vmcnt(0)
    s_branch L_rsentd
Lm_17:
    buffer_store_dwordx4 v[200:203], v21, s[40:43], s56 offen sc1
    s_branch Lm_18
Lm_29:
    buffer_store_dwordx4 v[204:207], v24, s[40:43], s25 offen sc1
    s_branch Lm_30
L_mlre:
    buffer_load_dwordx4 v[224:227], v51, s[40:43], s23 offen sc1
    s_sub_u32 s63, s63, 1
    s_cbranch_scc1 L_end
    s_waitcnt vmcnt(0)
    s_branch L_mlchk
L_codeend:
.section .rodata,"a"
.p2align 6
.amdhsa_kernel gated_mix__sliding_block_cached__dense_activation_relu__decode_kernel
  .amdhsa_next_free_vgpr 240
  .amdhsa_next_free_sgpr 102
  .amdhsa_accum_offset 240
  .amdhsa_group_segment_fixed_size 0
  .amdhsa_kernarg_size 96
  .amdhsa_user_sgpr_count 2
  .amdhsa_user_sgpr_kernarg_segment_ptr 1
  .amdhsa_system_sgpr_workgroup_id_x 1
.end_amdhsa_kernel
```
